```python
import torch

def _softmax(x, axis=-1):
    return torch.softmax(x, dim=axis)
def _gelu(x):
    return torch.nn.functional.gelu(x, approximate="tanh")
def _silu(x):
    return torch.nn.functional.silu(x)
def _sigmoid(x):
    return torch.sigmoid(x)
def _layernorm(x, axis=-1, eps=1e-5):
    m = x.mean(dim=axis, keepdim=True)
    v = x.var(dim=axis, keepdim=True, unbiased=False)
    return (x - m) / torch.sqrt(v + eps)
def _scatter_add(tgt, idx, src, axis=0):
    return tgt.clone().index_add_(axis, idx, src)
def _segment_sum(src, seg, n):
    out = torch.zeros((n,) + src.shape[1:], dtype=src.dtype)
    return out.index_add_(0, seg, src)
def _pad(x, pw):
    flat = tuple(v for pair in reversed(pw) for v in pair)
    return torch.nn.functional.pad(x, flat)

kernel_name = 'concat_heads__linear_attn_block__sliding_block__prompt'

def setup_inputs():

    _w = (lambda a: (lambda t: t.to(torch.bfloat16) if t.is_floating_point() else t)(torch.as_tensor(a)))
    def _A_setup():
        B, S, D = 1, 2048, 1024
        return {
            "x": _w((lambda *s: torch.randn(*s, dtype=torch.bfloat16) * 0.05)(B, S, D)),
            "wqkv": _w((lambda *s: torch.randn(*s, dtype=torch.bfloat16) * 1.6)(D, 3 * D)),
            "wo": _w((lambda *s: torch.randn(*s, dtype=torch.bfloat16) * 0.8)(D, D)),
        }
    _A_in = _A_setup()

    def _B_setup():
        B, S, D = 1, 2048, 1024
        return {
            "x": _w((lambda *s: torch.randn(*s, dtype=torch.bfloat16) * 0.2)(B, S, D)),
            "wqkv": _w((lambda *s: torch.randn(*s, dtype=torch.bfloat16) * 0.2)(D, 3 * D)),
            "wo": _w((lambda *s: torch.randn(*s, dtype=torch.bfloat16) * 0.05)(D, D)),
        }
    _B_in = _B_setup()

    return {
        "A_x": _A_in["x"],
        "A_wqkv": _A_in["wqkv"],
        "A_wo": _A_in["wo"],
        "B_x": _B_in["x"],
        "B_wqkv": _B_in["wqkv"],
        "B_wo": _B_in["wo"],
    }

def reference(A_x, A_wqkv, A_wo, B_x, B_wqkv, B_wo):
    def _A_ref(x, wqkv, wo):
        B, S, D = x.shape
        H = 32; Dh = D // H
        qkv = (lambda x, *d: x.permute(*d))((x @ wqkv).reshape(B, S, 3, H, Dh), 2, 0, 3, 1, 4)
        q, k, v = qkv[0], qkv[1], qkv[2]
        phi = lambda t: torch.where(t > 0, t + 1, torch.exp(t)) + 1e-6
        pq, pk = phi(q), phi(k)
        kv = torch.einsum("bhsd,bhse->bhde", pk, v)
        z = torch.einsum("bhsd->bhd", pk)
        num = torch.einsum("bhqd,bhde->bhqe", pq, kv)
        den = torch.einsum("bhqd,bhd->bhq", pq, z)[..., None] + 1e-6
        o = num / den
        return (lambda x, *d: x.permute(*d))(o, 0, 2, 1, 3).reshape(B, S, D) @ wo

    def _B_ref(x, wqkv, wo):
        B, S, D = x.shape
        H = 32; Dh = D // H; W = 256
        qkv = (lambda x, *d: x.permute(*d))((x @ wqkv).reshape(B, S, 3, H, Dh), 2, 0, 3, 1, 4)
        q, k, v = qkv[0], qkv[1], qkv[2]
        scores = torch.einsum("bhqd,bhkd->bhqk", q, k) * (Dh ** -0.5)
        idx = torch.arange(S)
        mask = (idx[:, None] - idx[None, :] >= 0) & (idx[:, None] - idx[None, :] < W)
        scores = torch.where(mask[None, None], scores, -1e9)
        p = _softmax(scores, axis=-1)
        o = torch.einsum("bhqk,bhkd->bhqd", p, v)
        return (lambda x, *d: x.permute(*d))(o, 0, 2, 1, 3).reshape(B, S, D) @ wo

    a = _A_ref(A_x, A_wqkv, A_wo)
    b = _B_ref(B_x, B_wqkv, B_wo)
    return torch.concatenate([a, b], axis=-1)
```

```asm
; @launch grid=(256,1,1) block=(512,1,1) lds=156672
.amdgcn_target "amdgcn-amd-amdhsa--gfx950"
.text
.globl concat_heads__linear_attn_block__sliding_block__prompt_kernel
.p2align 8
.type concat_heads__linear_attn_block__sliding_block__prompt_kernel,@function
concat_heads__linear_attn_block__sliding_block__prompt_kernel:
    s_load_dwordx4 s[36:39], s[0:1], 0
    s_load_dwordx4 s[40:43], s[0:1], 24
    s_load_dwordx4 s[44:47], s[0:1], 56
    s_load_dwordx2 s[48:49], s[0:1], 16
    s_load_dwordx4 s[84:87], s[0:1], 40
    s_getpc_b64 s[90:91]
    v_lshlrev_b32 v1, 7, v0
    v_cmp_gt_u32 vcc, 0x7100, v1
    s_nop 0
    s_and_saveexec_b64 s[58:59], vcc
    s_cbranch_execz L_concat_cpf
    global_load_dword v204, v1, s[90:91]
L_concat_cpf:
    s_mov_b64 exec, s[58:59]
    s_cmp_ge_u32 s2, 256
    s_cbranch_scc1 L_concat_exit
    v_lshrrev_b32 v188, 6, v0
    v_and_b32 v255, 63, v0
    v_readfirstlane_b32 s16, v188
    v_lshrrev_b32 v188, 3, v255
    v_and_b32 v189, 7, v255
    v_lshrrev_b32 v190, 4, v255
    s_lshr_b32 s32, s16, 2
    s_and_b32 s33, s16, 3
    s_mul_i32 s30, s32, 3
    s_xor_b32 s33, s33, s30
    s_lshl_b32 s30, s16, 5
    v_add_u32 v191, s30, v188
    v_lshlrev_b32 v191, 11, v191
    v_xor_b32 v192, v189, v190
    v_xor_b32 v193, 4, v192
    v_lshl_add_u32 v180, v192, 4, v191
    v_lshl_add_u32 v181, v193, 4, v191
    v_add_u32 v182, 30720, v180
    v_add_u32 v183, 46080, v181
    v_add_u32 v181, 15360, v181
    s_lshl_b32 s30, s16, 3
    v_add_u32 v191, s30, v188
    v_mul_u32_u24 v191, 6144, v191
    v_and_b32 v192, 1, v190
    s_and_b32 s30, s16, 1
    s_lshl_b32 s30, s30, 1
    v_or_b32 v192, s30, v192
    v_lshlrev_b32 v192, 1, v192
    v_xor_b32 v192, v189, v192
    v_lshl_add_u32 v184, v192, 4, v191
    v_add_u32 v185, 1024, v184
    v_add_u32 v186, 2048, v184
    s_lshl_b32 s27, s16, 12
    s_mul_i32 s28, s16, 3072
    s_add_u32 s28, s28, 98304
    s_waitcnt lgkmcnt(0)
    s_mov_b32 s52, s44
    s_mov_b32 s53, s45
    s_mov_b32 s54, 256
    s_mov_b32 s55, 0x00020000
    s_mov_b32 s12, s46
    s_mov_b32 s13, s47
    s_mov_b32 s14, 28311552
    s_mov_b32 s15, 0x00020000
    s_and_b32 s29, s2, 7
    s_lshr_b32 s30, s2, 3
    s_mov_b32 s57, s29
    s_and_b32 s17, s30, 1
    s_lshr_b32 s91, s30, 1
    s_lshr_b32 s18, s29, 2
    s_lshl_b32 s18, s18, 2
    s_and_b32 s31, s91, 3
    s_add_u32 s18, s18, s31
    s_and_b32 s19, s29, 3
    s_lshl_b32 s19, s19, 2
    s_lshr_b32 s31, s91, 2
    s_add_u32 s19, s19, s31
    s_cmp_eq_u32 s17, 1
    s_cselect_b32 s4, s40, s36
    s_cselect_b32 s5, s41, s37
    s_cselect_b32 s8, s42, s38
    s_cselect_b32 s9, s43, s39
    s_lshl_b32 s29, s18, 19
    s_add_u32 s4, s4, s29
    s_addc_u32 s5, s5, 0
    s_mov_b32 s6, 524288
    s_mov_b32 s7, 0x00020000
    s_lshl_b32 s29, s19, 7
    s_add_u32 s8, s8, s29
    s_addc_u32 s9, s9, 0
    s_sub_u32 s10, 6291456, s29
    s_mov_b32 s11, 0x00020000
    s_mov_b32 s83, s17
    s_cmp_eq_u32 s83, 1
    s_cselect_b32 s84, s84, s48
    s_cselect_b32 s85, s85, s49
    s_and_b32 s82, s2, 7
    s_mul_i32 s82, s82, 2
    s_and_b32 s82, s82, 15
    s_add_u32 s20, s82, 0
    s_and_b32 s20, s20, 15
    s_mul_i32 s20, s20, 128
    s_add_u32 m0, s27, 0
    s_nop 0
    buffer_load_dwordx4 v180, s[4:7], s20 offen offset:0 lds
    buffer_load_dwordx4 v181, s[4:7], s20 offen offset:1024 lds
    buffer_load_dwordx4 v182, s[4:7], s20 offen offset:2048 lds
    buffer_load_dwordx4 v183, s[4:7], s20 offen offset:3072 lds
    s_add_u32 s21, s82, 0
    s_and_b32 s21, s21, 15
    s_mul_i32 s21, s21, 393216
    s_add_u32 m0, s28, 0
    s_nop 0
    buffer_load_dwordx4 v184, s[8:11], s21 offen offset:0 lds
    buffer_load_dwordx4 v185, s[8:11], s21 offen offset:1024 lds
    buffer_load_dwordx4 v186, s[8:11], s21 offen offset:2048 lds
    s_add_u32 s20, s82, 1
    s_and_b32 s20, s20, 15
    s_mul_i32 s20, s20, 128
    s_add_u32 m0, s27, 32768
    s_nop 0
    buffer_load_dwordx4 v180, s[4:7], s20 offen offset:0 lds
    buffer_load_dwordx4 v181, s[4:7], s20 offen offset:1024 lds
    buffer_load_dwordx4 v182, s[4:7], s20 offen offset:2048 lds
    buffer_load_dwordx4 v183, s[4:7], s20 offen offset:3072 lds
    s_add_u32 s21, s82, 1
    s_and_b32 s21, s21, 15
    s_mul_i32 s21, s21, 393216
    s_add_u32 m0, s28, 24576
    s_nop 0
    buffer_load_dwordx4 v184, s[8:11], s21 offen offset:0 lds
    buffer_load_dwordx4 v185, s[8:11], s21 offen offset:1024 lds
    buffer_load_dwordx4 v186, s[8:11], s21 offen offset:2048 lds
    s_add_u32 s20, s82, 2
    s_and_b32 s20, s20, 15
    s_mul_i32 s20, s20, 128
    s_add_u32 m0, s27, 65536
    s_nop 0
    buffer_load_dwordx4 v180, s[4:7], s20 offen offset:0 lds
    buffer_load_dwordx4 v181, s[4:7], s20 offen offset:1024 lds
    buffer_load_dwordx4 v182, s[4:7], s20 offen offset:2048 lds
    buffer_load_dwordx4 v183, s[4:7], s20 offen offset:3072 lds
    s_lshl_b32 s29, s18, 4
    s_add_u32 s29, s29, s19
    s_lshl_b32 s29, s29, 3
    v_and_b32 v188, 1, v255
    v_lshlrev_b32 v188, 10, v188
    v_add_u32 v188, 384, v188
    v_lshrrev_b32 v189, 1, v255
    v_mov_b32 v191, 0x7ffffff0
    s_cmp_lt_u32 s16, 3
    s_cbranch_scc0 L_concat_pp_x
    v_add_u32 v190, s29, v189
    v_mul_u32_u24 v190, 6144, v190
    s_lshl_b32 s30, s16, 11
    v_add_u32 v190, s30, v190
    v_add_u32 v199, v190, v188
    v_cmp_gt_u32 vcc, 16, v255
    s_lshl_b32 s30, s19, 7
    s_sub_u32 s96, s8, s30
    s_subb_u32 s97, s9, 0
    s_mov_b32 s98, 6291456
    s_branch L_concat_pp_d
L_concat_pp_x:
    s_cmp_eq_u32 s16, 3
    s_cbranch_scc0 L_concat_pp_o
    s_lshl_b32 s30, s19, 4
    v_add_u32 v190, s30, v189
    v_lshl_add_u32 v199, v190, 11, v188
    v_cmp_gt_u32 vcc, 32, v255
    s_mov_b32 s96, s4
    s_mov_b32 s97, s5
    s_mov_b32 s98, s6
    s_branch L_concat_pp_d
L_concat_pp_o:
    v_add_u32 v190, s29, v189
    v_lshl_add_u32 v199, v190, 11, v188
    s_cmp_eq_u32 s16, 4
    s_cselect_b32 s30, 16, 0
    v_cmp_gt_u32 vcc, s30, v255
    s_mov_b32 s96, s84
    s_mov_b32 s97, s85
    s_mov_b32 s98, 2097152
L_concat_pp_d:
    v_cndmask_b32 v199, v191, v199, vcc
    s_mov_b32 s99, 0x00020000
    s_and_b32 s29, s57, 1
    s_lshl_b32 s29, s29, 3
    s_and_b32 s30, s91, 1
    s_and_b32 s57, s57, 6
    s_add_u32 s57, s57, s30
    s_lshr_b32 s91, s91, 1
    s_add_u32 s91, s91, s29
    s_lshl_b32 s56, s17, 7
    s_lshl_b32 s29, s18, 4
    s_add_u32 s56, s56, s29
    s_add_u32 s56, s56, s19
    s_lshl_b32 s100, s17, 3
    s_add_u32 s100, s100, s18
    s_lshl_b32 s100, s100, 7
    s_add_u32 s100, s100, s19
    s_add_u32 s100, s100, 18350080
    s_lshl_b32 s29, s19, 7
    s_add_u32 s29, s29, s18
    s_add_u32 s29, s29, 18352128
    s_lshl_b32 s30, s18, 4
    s_add_u32 s30, s30, s19
    s_lshl_b32 s30, s30, 7
    s_add_u32 s30, s30, 18354176
    s_cmp_eq_u32 s17, 1
    s_cselect_b32 s101, s30, s29
    s_cmp_lg_u32 s16, 7
    s_cbranch_scc1 L_concat_clr_done
    s_mov_b64 s[58:59], exec
    s_mov_b64 exec, 1
    v_mov_b32 v208, 0
    s_and_b32 s29, s100, 3
    s_lshl_b32 s29, s29, 3
    s_lshl_b32 s29, 0xff, s29
    s_not_b32 s29, s29
    s_andn2_b32 s30, s100, 3
    v_mov_b32 v205, s29
    buffer_atomic_and v205, v208, s[12:15], s30 offen offset:0 sc0
    v_mov_b32 v206, s29
    buffer_atomic_and v206, v208, s[12:15], s30 offen offset:16 sc0
    s_and_b32 s29, s101, 3
    s_lshl_b32 s29, s29, 3
    s_lshl_b32 s29, 0xff, s29
    s_not_b32 s29, s29
    s_andn2_b32 s30, s101, 3
    v_mov_b32 v207, s29
    buffer_atomic_and v207, v208, s[12:15], s30 offen offset:0 sc0
    s_mov_b64 exec, s[58:59]
L_concat_clr_done:
    s_add_u32 s20, s82, 3
    s_and_b32 s20, s20, 15
    s_mul_i32 s20, s20, 128
    s_add_u32 s21, s82, 2
    s_and_b32 s21, s21, 15
    s_mul_i32 s21, s21, 393216
    s_mov_b32 s22, 0
    s_mov_b32 s23, 0
    s_mov_b32 s26, 0
    v_and_b32 v188, 15, v255
    v_lshrrev_b32 v189, 4, v255
    s_lshl_b32 s29, s33, 6
    v_add_u32 v190, s29, v188
    v_lshlrev_b32 v190, 7, v190
    v_lshrrev_b32 v191, 1, v188
    v_xor_b32 v191, v191, v189
    v_lshl_add_u32 v176, v191, 4, v190
    v_xor_b32 v191, 4, v191
    v_lshl_add_u32 v177, v191, 4, v190
    v_mul_u32_u24 v190, 3072, v189
    v_bfe_u32 v191, v255, 2, 2
    v_lshl_add_u32 v190, v191, 7, v190
    v_and_b32 v192, 3, v255
    v_lshl_add_u32 v190, v192, 3, v190
    v_add_u32 v190, 98304, v190
    v_lshrrev_b32 v191, 1, v191
    v_and_b32 v192, 1, v189
    v_lshl_or_b32 v191, v192, 1, v191
    s_lshl_b32 s29, s32, 1
    v_xor_b32 v191, s29, v191
    v_lshl_add_u32 v178, v191, 5, v190
    v_xor_b32 v191, 1, v191
    v_lshl_add_u32 v179, v191, 5, v190
    s_cmp_eq_u32 s17, 1
    s_cbranch_scc1 L_concat_probB
    s_waitcnt vmcnt(11)
    s_barrier
    ds_read_b64_tr_b16 v[128:129], v178 offset:0
    ds_read_b64_tr_b16 v[130:131], v178 offset:512
    ds_read_b128 v[96:99], v176 offset:0
    ds_read_b128 v[100:103], v176 offset:2048
    ds_read_b128 v[104:107], v176 offset:4096
    ds_read_b128 v[108:111], v176 offset:6144
    ds_read_b64_tr_b16 v[132:133], v179 offset:0
    ds_read_b64_tr_b16 v[134:135], v179 offset:512
    ds_read_b64_tr_b16 v[136:137], v178 offset:1024
    ds_read_b64_tr_b16 v[138:139], v178 offset:1536
    ds_read_b64_tr_b16 v[140:141], v179 offset:1024
    ds_read_b64_tr_b16 v[142:143], v179 offset:1536
    ds_read_b64_tr_b16 v[144:145], v178 offset:2048
    ds_read_b64_tr_b16 v[146:147], v178 offset:2560
    ds_read_b64_tr_b16 v[148:149], v179 offset:2048
    ds_read_b64_tr_b16 v[150:151], v179 offset:2560
    s_waitcnt lgkmcnt(0)
    v_mfma_f32_16x16x32_bf16 v[0:3], v[128:131], v[96:99], 0
    ds_read_b64_tr_b16 v[152:153], v178 offset:12288
    v_mfma_f32_16x16x32_bf16 v[4:7], v[128:131], v[100:103], 0
    ds_read_b64_tr_b16 v[154:155], v178 offset:12800
    v_mfma_f32_16x16x32_bf16 v[8:11], v[128:131], v[104:107], 0
    ds_read_b128 v[112:115], v177 offset:0
    v_mfma_f32_16x16x32_bf16 v[12:15], v[128:131], v[108:111], 0
    ds_read_b128 v[116:119], v177 offset:2048
    v_mfma_f32_16x16x32_bf16 v[28:31], v[132:135], v[108:111], 0
    ds_read_b128 v[120:123], v177 offset:4096
    v_mfma_f32_16x16x32_bf16 v[24:27], v[132:135], v[104:107], 0
    ds_read_b128 v[124:127], v177 offset:6144
    v_mfma_f32_16x16x32_bf16 v[20:23], v[132:135], v[100:103], 0
    ds_read_b64_tr_b16 v[156:157], v179 offset:12288
    v_mfma_f32_16x16x32_bf16 v[16:19], v[132:135], v[96:99], 0
    ds_read_b64_tr_b16 v[158:159], v179 offset:12800
    v_mfma_f32_16x16x32_bf16 v[32:35], v[96:99], v[136:139], 0
    ds_read_b64_tr_b16 v[160:161], v178 offset:13312
    v_mfma_f32_16x16x32_bf16 v[48:51], v[96:99], v[140:143], 0
    ds_read_b64_tr_b16 v[162:163], v178 offset:13824
    v_mfma_f32_16x16x32_bf16 v[64:67], v[96:99], v[144:147], 0
    ds_read_b64_tr_b16 v[164:165], v179 offset:13312
    v_mfma_f32_16x16x32_bf16 v[80:83], v[96:99], v[148:151], 0
    ds_read_b64_tr_b16 v[166:167], v179 offset:13824
    v_mfma_f32_16x16x32_bf16 v[84:87], v[100:103], v[148:151], 0
    ds_read_b64_tr_b16 v[168:169], v178 offset:14336
    v_mfma_f32_16x16x32_bf16 v[68:71], v[100:103], v[144:147], 0
    ds_read_b64_tr_b16 v[170:171], v178 offset:14848
    v_mfma_f32_16x16x32_bf16 v[52:55], v[100:103], v[140:143], 0
    ds_read_b64_tr_b16 v[172:173], v179 offset:14336
    v_mfma_f32_16x16x32_bf16 v[36:39], v[100:103], v[136:139], 0
    ds_read_b64_tr_b16 v[174:175], v179 offset:14848
    v_mfma_f32_16x16x32_bf16 v[40:43], v[104:107], v[136:139], 0
    s_add_u32 s29, s22, 32768
    s_cmp_eq_u32 s29, 98304
    s_cselect_b32 s29, 0, s29
    s_sub_u32 s24, s29, s22
    s_lshl_b32 s30, s23, 1
    s_sub_u32 s25, 24576, s30
    v_mfma_f32_16x16x32_bf16 v[56:59], v[104:107], v[140:143], 0
    v_mfma_f32_16x16x32_bf16 v[72:75], v[104:107], v[144:147], 0
    v_add_u32 v176, s24, v176
    v_mfma_f32_16x16x32_bf16 v[88:91], v[104:107], v[148:151], 0
    v_add_u32 v177, s24, v177
    v_mfma_f32_16x16x32_bf16 v[92:95], v[108:111], v[148:151], 0
    v_add_u32 v178, s25, v178
    v_mfma_f32_16x16x32_bf16 v[76:79], v[108:111], v[144:147], 0
    v_add_u32 v179, s25, v179
    v_mfma_f32_16x16x32_bf16 v[60:63], v[108:111], v[140:143], 0
    v_mfma_f32_16x16x32_bf16 v[44:47], v[108:111], v[136:139], 0
    s_waitcnt vmcnt(4) lgkmcnt(0)
    s_barrier
    v_mfma_f32_16x16x32_bf16 v[0:3], v[152:155], v[112:115], v[0:3]
    ds_read_b64_tr_b16 v[128:129], v178 offset:0
    s_add_u32 m0, s28, s23
    s_nop 0
    buffer_load_dwordx4 v184, s[8:11], s21 offen offset:0 lds
    v_mfma_f32_16x16x32_bf16 v[4:7], v[152:155], v[116:119], v[4:7]
    ds_read_b64_tr_b16 v[130:131], v178 offset:512
    v_mfma_f32_16x16x32_bf16 v[8:11], v[152:155], v[120:123], v[8:11]
    ds_read_b128 v[96:99], v176 offset:0
    buffer_load_dwordx4 v185, s[8:11], s21 offen offset:1024 lds
    v_mfma_f32_16x16x32_bf16 v[12:15], v[152:155], v[124:127], v[12:15]
    ds_read_b128 v[100:103], v176 offset:2048
    v_mfma_f32_16x16x32_bf16 v[28:31], v[156:159], v[124:127], v[28:31]
    ds_read_b128 v[104:107], v176 offset:4096
    buffer_load_dwordx4 v186, s[8:11], s21 offen offset:2048 lds
    v_mfma_f32_16x16x32_bf16 v[24:27], v[156:159], v[120:123], v[24:27]
    ds_read_b128 v[108:111], v176 offset:6144
    v_mfma_f32_16x16x32_bf16 v[20:23], v[156:159], v[116:119], v[20:23]
    ds_read_b64_tr_b16 v[132:133], v179 offset:0
    s_add_u32 s21, s21, 393216
    s_cmp_eq_u32 s21, 6291456
    s_cselect_b32 s21, 0, s21
    v_mfma_f32_16x16x32_bf16 v[16:19], v[156:159], v[112:115], v[16:19]
    ds_read_b64_tr_b16 v[134:135], v179 offset:512
    v_mfma_f32_16x16x32_bf16 v[32:35], v[112:115], v[160:163], v[32:35]
    ds_read_b64_tr_b16 v[136:137], v178 offset:1024
    v_mfma_f32_16x16x32_bf16 v[48:51], v[112:115], v[164:167], v[48:51]
    ds_read_b64_tr_b16 v[138:139], v178 offset:1536
    v_mfma_f32_16x16x32_bf16 v[64:67], v[112:115], v[168:171], v[64:67]
    ds_read_b64_tr_b16 v[140:141], v179 offset:1024
    v_mfma_f32_16x16x32_bf16 v[80:83], v[112:115], v[172:175], v[80:83]
    ds_read_b64_tr_b16 v[142:143], v179 offset:1536
    v_mfma_f32_16x16x32_bf16 v[84:87], v[116:119], v[172:175], v[84:87]
    ds_read_b64_tr_b16 v[144:145], v178 offset:2048
    v_mfma_f32_16x16x32_bf16 v[68:71], v[116:119], v[168:171], v[68:71]
    ds_read_b64_tr_b16 v[146:147], v178 offset:2560
    v_mfma_f32_16x16x32_bf16 v[52:55], v[116:119], v[164:167], v[52:55]
    ds_read_b64_tr_b16 v[148:149], v179 offset:2048
    v_mfma_f32_16x16x32_bf16 v[36:39], v[116:119], v[160:163], v[36:39]
    ds_read_b64_tr_b16 v[150:151], v179 offset:2560
    v_mfma_f32_16x16x32_bf16 v[40:43], v[120:123], v[160:163], v[40:43]
    v_mfma_f32_16x16x32_bf16 v[56:59], v[120:123], v[164:167], v[56:59]
    buffer_load_dword v204, v199, s[96:99], 0 offen
    v_mfma_f32_16x16x32_bf16 v[72:75], v[120:123], v[168:171], v[72:75]
    v_mfma_f32_16x16x32_bf16 v[88:91], v[120:123], v[172:175], v[88:91]
    v_mfma_f32_16x16x32_bf16 v[92:95], v[124:127], v[172:175], v[92:95]
    v_mfma_f32_16x16x32_bf16 v[76:79], v[124:127], v[168:171], v[76:79]
    v_mfma_f32_16x16x32_bf16 v[60:63], v[124:127], v[164:167], v[60:63]
    s_mov_b32 s51, s22
    v_mfma_f32_16x16x32_bf16 v[44:47], v[124:127], v[160:163], v[44:47]
    s_add_u32 s22, s22, s24
    s_add_u32 s23, s23, s25
    s_waitcnt lgkmcnt(0)
    s_mov_b32 s26, 1
    v_mfma_f32_16x16x32_bf16 v[0:3], v[128:131], v[96:99], v[0:3]
    ds_read_b64_tr_b16 v[152:153], v178 offset:12288
    v_mfma_f32_16x16x32_bf16 v[4:7], v[128:131], v[100:103], v[4:7]
    ds_read_b64_tr_b16 v[154:155], v178 offset:12800
    s_add_u32 m0, s27, s51
    s_nop 0
    buffer_load_dwordx4 v180, s[4:7], s20 offen offset:0 lds
    v_mfma_f32_16x16x32_bf16 v[8:11], v[128:131], v[104:107], v[8:11]
    ds_read_b128 v[112:115], v177 offset:0
    v_mfma_f32_16x16x32_bf16 v[12:15], v[128:131], v[108:111], v[12:15]
    ds_read_b128 v[116:119], v177 offset:2048
    v_mfma_f32_16x16x32_bf16 v[28:31], v[132:135], v[108:111], v[28:31]
    ds_read_b128 v[120:123], v177 offset:4096
    buffer_load_dwordx4 v181, s[4:7], s20 offen offset:1024 lds
    v_mfma_f32_16x16x32_bf16 v[24:27], v[132:135], v[104:107], v[24:27]
    ds_read_b128 v[124:127], v177 offset:6144
    v_mfma_f32_16x16x32_bf16 v[20:23], v[132:135], v[100:103], v[20:23]
    ds_read_b64_tr_b16 v[156:157], v179 offset:12288
    v_mfma_f32_16x16x32_bf16 v[16:19], v[132:135], v[96:99], v[16:19]
    ds_read_b64_tr_b16 v[158:159], v179 offset:12800
    buffer_load_dwordx4 v182, s[4:7], s20 offen offset:2048 lds
    v_mfma_f32_16x16x32_bf16 v[32:35], v[96:99], v[136:139], v[32:35]
    ds_read_b64_tr_b16 v[160:161], v178 offset:13312
    v_mfma_f32_16x16x32_bf16 v[48:51], v[96:99], v[140:143], v[48:51]
    ds_read_b64_tr_b16 v[162:163], v178 offset:13824
    v_mfma_f32_16x16x32_bf16 v[64:67], v[96:99], v[144:147], v[64:67]
    ds_read_b64_tr_b16 v[164:165], v179 offset:13312
    buffer_load_dwordx4 v183, s[4:7], s20 offen offset:3072 lds
    v_mfma_f32_16x16x32_bf16 v[80:83], v[96:99], v[148:151], v[80:83]
    ds_read_b64_tr_b16 v[166:167], v179 offset:13824
    v_mfma_f32_16x16x32_bf16 v[84:87], v[100:103], v[148:151], v[84:87]
    ds_read_b64_tr_b16 v[168:169], v178 offset:14336
    v_mfma_f32_16x16x32_bf16 v[68:71], v[100:103], v[144:147], v[68:71]
    ds_read_b64_tr_b16 v[170:171], v178 offset:14848
    s_add_u32 s20, s20, 128
    s_and_b32 s20, s20, 0x7ff
    v_mfma_f32_16x16x32_bf16 v[52:55], v[100:103], v[140:143], v[52:55]
    ds_read_b64_tr_b16 v[172:173], v179 offset:14336
    v_mfma_f32_16x16x32_bf16 v[36:39], v[100:103], v[136:139], v[36:39]
    ds_read_b64_tr_b16 v[174:175], v179 offset:14848
    v_mfma_f32_16x16x32_bf16 v[40:43], v[104:107], v[136:139], v[40:43]
    s_add_u32 s29, s22, 32768
    s_cmp_eq_u32 s29, 98304
    s_cselect_b32 s29, 0, s29
    s_sub_u32 s24, s29, s22
    s_lshl_b32 s30, s23, 1
    s_sub_u32 s25, 24576, s30
    v_mfma_f32_16x16x32_bf16 v[56:59], v[104:107], v[140:143], v[56:59]
    v_mfma_f32_16x16x32_bf16 v[72:75], v[104:107], v[144:147], v[72:75]
    v_add_u32 v176, s24, v176
    v_mfma_f32_16x16x32_bf16 v[88:91], v[104:107], v[148:151], v[88:91]
    v_add_u32 v177, s24, v177
    v_mfma_f32_16x16x32_bf16 v[92:95], v[108:111], v[148:151], v[92:95]
    v_add_u32 v178, s25, v178
    v_mfma_f32_16x16x32_bf16 v[76:79], v[108:111], v[144:147], v[76:79]
    v_add_u32 v179, s25, v179
    v_mfma_f32_16x16x32_bf16 v[60:63], v[108:111], v[140:143], v[60:63]
    v_mfma_f32_16x16x32_bf16 v[44:47], v[108:111], v[136:139], v[44:47]
    s_waitcnt vmcnt(5) lgkmcnt(0)
    s_barrier
    s_cmp_eq_u32 s26, 1
    s_cbranch_scc0 L_concat_annhA
    s_cmp_lg_u32 s16, 7
    s_cbranch_scc1 L_concat_ann_doneA
    s_mov_b64 s[58:59], exec
    s_mov_b64 exec, 1
    s_and_b32 s34, s56, 3
    s_lshl_b32 s34, s34, 3
    s_lshl_b32 s34, 1, s34
    s_andn2_b32 s35, s56, 3
    v_mov_b32 v205, s34
    v_mov_b32 v206, 0
    buffer_atomic_or v205, v206, s[52:55], s35 offen
    s_mov_b64 exec, s[58:59]
    s_nop 3
L_concat_ann_doneA:
L_concat_annhA:
    v_mfma_f32_16x16x32_bf16 v[0:3], v[152:155], v[112:115], v[0:3]
    ds_read_b64_tr_b16 v[128:129], v178 offset:0
    s_add_u32 m0, s28, s23
    s_nop 0
    buffer_load_dwordx4 v184, s[8:11], s21 offen offset:0 lds
    v_mfma_f32_16x16x32_bf16 v[4:7], v[152:155], v[116:119], v[4:7]
    ds_read_b64_tr_b16 v[130:131], v178 offset:512
    v_mfma_f32_16x16x32_bf16 v[8:11], v[152:155], v[120:123], v[8:11]
    ds_read_b128 v[96:99], v176 offset:0
    buffer_load_dwordx4 v185, s[8:11], s21 offen offset:1024 lds
    v_mfma_f32_16x16x32_bf16 v[12:15], v[152:155], v[124:127], v[12:15]
    ds_read_b128 v[100:103], v176 offset:2048
    v_mfma_f32_16x16x32_bf16 v[28:31], v[156:159], v[124:127], v[28:31]
    ds_read_b128 v[104:107], v176 offset:4096
    buffer_load_dwordx4 v186, s[8:11], s21 offen offset:2048 lds
    v_mfma_f32_16x16x32_bf16 v[24:27], v[156:159], v[120:123], v[24:27]
    ds_read_b128 v[108:111], v176 offset:6144
    v_mfma_f32_16x16x32_bf16 v[20:23], v[156:159], v[116:119], v[20:23]
    ds_read_b64_tr_b16 v[132:133], v179 offset:0
    s_add_u32 s21, s21, 393216
    s_cmp_eq_u32 s21, 6291456
    s_cselect_b32 s21, 0, s21
    v_mfma_f32_16x16x32_bf16 v[16:19], v[156:159], v[112:115], v[16:19]
    ds_read_b64_tr_b16 v[134:135], v179 offset:512
    v_mfma_f32_16x16x32_bf16 v[32:35], v[112:115], v[160:163], v[32:35]
    ds_read_b64_tr_b16 v[136:137], v178 offset:1024
    v_mfma_f32_16x16x32_bf16 v[48:51], v[112:115], v[164:167], v[48:51]
    ds_read_b64_tr_b16 v[138:139], v178 offset:1536
    v_mfma_f32_16x16x32_bf16 v[64:67], v[112:115], v[168:171], v[64:67]
    ds_read_b64_tr_b16 v[140:141], v179 offset:1024
    v_mfma_f32_16x16x32_bf16 v[80:83], v[112:115], v[172:175], v[80:83]
    ds_read_b64_tr_b16 v[142:143], v179 offset:1536
    v_mfma_f32_16x16x32_bf16 v[84:87], v[116:119], v[172:175], v[84:87]
    ds_read_b64_tr_b16 v[144:145], v178 offset:2048
    v_mfma_f32_16x16x32_bf16 v[68:71], v[116:119], v[168:171], v[68:71]
    ds_read_b64_tr_b16 v[146:147], v178 offset:2560
    v_mfma_f32_16x16x32_bf16 v[52:55], v[116:119], v[164:167], v[52:55]
    ds_read_b64_tr_b16 v[148:149], v179 offset:2048
    v_mfma_f32_16x16x32_bf16 v[36:39], v[116:119], v[160:163], v[36:39]
    ds_read_b64_tr_b16 v[150:151], v179 offset:2560
    v_mfma_f32_16x16x32_bf16 v[40:43], v[120:123], v[160:163], v[40:43]
    v_mfma_f32_16x16x32_bf16 v[56:59], v[120:123], v[164:167], v[56:59]
    v_mfma_f32_16x16x32_bf16 v[72:75], v[120:123], v[168:171], v[72:75]
    v_mfma_f32_16x16x32_bf16 v[88:91], v[120:123], v[172:175], v[88:91]
    v_mfma_f32_16x16x32_bf16 v[92:95], v[124:127], v[172:175], v[92:95]
    v_mfma_f32_16x16x32_bf16 v[76:79], v[124:127], v[168:171], v[76:79]
    v_mfma_f32_16x16x32_bf16 v[60:63], v[124:127], v[164:167], v[60:63]
    s_mov_b32 s51, s22
    v_mfma_f32_16x16x32_bf16 v[44:47], v[124:127], v[160:163], v[44:47]
    s_add_u32 s22, s22, s24
    s_add_u32 s23, s23, s25
    s_waitcnt lgkmcnt(0)
    s_mov_b32 s26, 2
L_concat_g1_A:
    v_mfma_f32_16x16x32_bf16 v[0:3], v[128:131], v[96:99], v[0:3]
    ds_read_b64_tr_b16 v[152:153], v178 offset:12288
    v_mfma_f32_16x16x32_bf16 v[4:7], v[128:131], v[100:103], v[4:7]
    ds_read_b64_tr_b16 v[154:155], v178 offset:12800
    s_add_u32 m0, s27, s51
    s_nop 0
    buffer_load_dwordx4 v180, s[4:7], s20 offen offset:0 lds
    v_mfma_f32_16x16x32_bf16 v[8:11], v[128:131], v[104:107], v[8:11]
    ds_read_b128 v[112:115], v177 offset:0
    v_mfma_f32_16x16x32_bf16 v[12:15], v[128:131], v[108:111], v[12:15]
    ds_read_b128 v[116:119], v177 offset:2048
    v_mfma_f32_16x16x32_bf16 v[28:31], v[132:135], v[108:111], v[28:31]
    ds_read_b128 v[120:123], v177 offset:4096
    buffer_load_dwordx4 v181, s[4:7], s20 offen offset:1024 lds
    v_mfma_f32_16x16x32_bf16 v[24:27], v[132:135], v[104:107], v[24:27]
    ds_read_b128 v[124:127], v177 offset:6144
    v_mfma_f32_16x16x32_bf16 v[20:23], v[132:135], v[100:103], v[20:23]
    ds_read_b64_tr_b16 v[156:157], v179 offset:12288
    v_mfma_f32_16x16x32_bf16 v[16:19], v[132:135], v[96:99], v[16:19]
    ds_read_b64_tr_b16 v[158:159], v179 offset:12800
    buffer_load_dwordx4 v182, s[4:7], s20 offen offset:2048 lds
    v_mfma_f32_16x16x32_bf16 v[32:35], v[96:99], v[136:139], v[32:35]
    ds_read_b64_tr_b16 v[160:161], v178 offset:13312
    v_mfma_f32_16x16x32_bf16 v[48:51], v[96:99], v[140:143], v[48:51]
    ds_read_b64_tr_b16 v[162:163], v178 offset:13824
    v_mfma_f32_16x16x32_bf16 v[64:67], v[96:99], v[144:147], v[64:67]
    ds_read_b64_tr_b16 v[164:165], v179 offset:13312
    buffer_load_dwordx4 v183, s[4:7], s20 offen offset:3072 lds
    v_mfma_f32_16x16x32_bf16 v[80:83], v[96:99], v[148:151], v[80:83]
    ds_read_b64_tr_b16 v[166:167], v179 offset:13824
    v_mfma_f32_16x16x32_bf16 v[84:87], v[100:103], v[148:151], v[84:87]
    ds_read_b64_tr_b16 v[168:169], v178 offset:14336
    v_mfma_f32_16x16x32_bf16 v[68:71], v[100:103], v[144:147], v[68:71]
    ds_read_b64_tr_b16 v[170:171], v178 offset:14848
    s_add_u32 s20, s20, 128
    s_and_b32 s20, s20, 0x7ff
    v_mfma_f32_16x16x32_bf16 v[52:55], v[100:103], v[140:143], v[52:55]
    ds_read_b64_tr_b16 v[172:173], v179 offset:14336
    v_mfma_f32_16x16x32_bf16 v[36:39], v[100:103], v[136:139], v[36:39]
    ds_read_b64_tr_b16 v[174:175], v179 offset:14848
    v_mfma_f32_16x16x32_bf16 v[40:43], v[104:107], v[136:139], v[40:43]
    s_add_u32 s29, s22, 32768
    s_cmp_eq_u32 s29, 98304
    s_cselect_b32 s29, 0, s29
    s_sub_u32 s24, s29, s22
    s_lshl_b32 s30, s23, 1
    s_sub_u32 s25, 24576, s30
    v_mfma_f32_16x16x32_bf16 v[56:59], v[104:107], v[140:143], v[56:59]
    v_mfma_f32_16x16x32_bf16 v[72:75], v[104:107], v[144:147], v[72:75]
    v_add_u32 v176, s24, v176
    v_mfma_f32_16x16x32_bf16 v[88:91], v[104:107], v[148:151], v[88:91]
    v_add_u32 v177, s24, v177
    v_mfma_f32_16x16x32_bf16 v[92:95], v[108:111], v[148:151], v[92:95]
    v_add_u32 v178, s25, v178
    v_mfma_f32_16x16x32_bf16 v[76:79], v[108:111], v[144:147], v[76:79]
    v_add_u32 v179, s25, v179
    v_mfma_f32_16x16x32_bf16 v[60:63], v[108:111], v[140:143], v[60:63]
    v_mfma_f32_16x16x32_bf16 v[44:47], v[108:111], v[136:139], v[44:47]
    s_waitcnt vmcnt(4) lgkmcnt(0)
    s_barrier
    v_mfma_f32_16x16x32_bf16 v[0:3], v[152:155], v[112:115], v[0:3]
    ds_read_b64_tr_b16 v[128:129], v178 offset:0
    s_add_u32 m0, s28, s23
    s_nop 0
    buffer_load_dwordx4 v184, s[8:11], s21 offen offset:0 lds
    v_mfma_f32_16x16x32_bf16 v[4:7], v[152:155], v[116:119], v[4:7]
    ds_read_b64_tr_b16 v[130:131], v178 offset:512
    v_mfma_f32_16x16x32_bf16 v[8:11], v[152:155], v[120:123], v[8:11]
    ds_read_b128 v[96:99], v176 offset:0
    buffer_load_dwordx4 v185, s[8:11], s21 offen offset:1024 lds
    v_mfma_f32_16x16x32_bf16 v[12:15], v[152:155], v[124:127], v[12:15]
    ds_read_b128 v[100:103], v176 offset:2048
    v_mfma_f32_16x16x32_bf16 v[28:31], v[156:159], v[124:127], v[28:31]
    ds_read_b128 v[104:107], v176 offset:4096
    buffer_load_dwordx4 v186, s[8:11], s21 offen offset:2048 lds
    v_mfma_f32_16x16x32_bf16 v[24:27], v[156:159], v[120:123], v[24:27]
    ds_read_b128 v[108:111], v176 offset:6144
    v_mfma_f32_16x16x32_bf16 v[20:23], v[156:159], v[116:119], v[20:23]
    ds_read_b64_tr_b16 v[132:133], v179 offset:0
    s_add_u32 s21, s21, 393216
    s_cmp_eq_u32 s21, 6291456
    s_cselect_b32 s21, 0, s21
    v_mfma_f32_16x16x32_bf16 v[16:19], v[156:159], v[112:115], v[16:19]
    ds_read_b64_tr_b16 v[134:135], v179 offset:512
    v_mfma_f32_16x16x32_bf16 v[32:35], v[112:115], v[160:163], v[32:35]
    ds_read_b64_tr_b16 v[136:137], v178 offset:1024
    v_mfma_f32_16x16x32_bf16 v[48:51], v[112:115], v[164:167], v[48:51]
    ds_read_b64_tr_b16 v[138:139], v178 offset:1536
    v_mfma_f32_16x16x32_bf16 v[64:67], v[112:115], v[168:171], v[64:67]
    ds_read_b64_tr_b16 v[140:141], v179 offset:1024
    v_mfma_f32_16x16x32_bf16 v[80:83], v[112:115], v[172:175], v[80:83]
    ds_read_b64_tr_b16 v[142:143], v179 offset:1536
    v_mfma_f32_16x16x32_bf16 v[84:87], v[116:119], v[172:175], v[84:87]
    ds_read_b64_tr_b16 v[144:145], v178 offset:2048
    v_mfma_f32_16x16x32_bf16 v[68:71], v[116:119], v[168:171], v[68:71]
    ds_read_b64_tr_b16 v[146:147], v178 offset:2560
    v_mfma_f32_16x16x32_bf16 v[52:55], v[116:119], v[164:167], v[52:55]
    ds_read_b64_tr_b16 v[148:149], v179 offset:2048
    v_mfma_f32_16x16x32_bf16 v[36:39], v[116:119], v[160:163], v[36:39]
    ds_read_b64_tr_b16 v[150:151], v179 offset:2560
    v_mfma_f32_16x16x32_bf16 v[40:43], v[120:123], v[160:163], v[40:43]
    v_mfma_f32_16x16x32_bf16 v[56:59], v[120:123], v[164:167], v[56:59]
    v_mfma_f32_16x16x32_bf16 v[72:75], v[120:123], v[168:171], v[72:75]
    v_mfma_f32_16x16x32_bf16 v[88:91], v[120:123], v[172:175], v[88:91]
    v_mfma_f32_16x16x32_bf16 v[92:95], v[124:127], v[172:175], v[92:95]
    v_mfma_f32_16x16x32_bf16 v[76:79], v[124:127], v[168:171], v[76:79]
    v_mfma_f32_16x16x32_bf16 v[60:63], v[124:127], v[164:167], v[60:63]
    s_mov_b32 s51, s22
    v_mfma_f32_16x16x32_bf16 v[44:47], v[124:127], v[160:163], v[44:47]
    s_add_u32 s22, s22, s24
    s_add_u32 s23, s23, s25
    s_waitcnt lgkmcnt(0)
    s_add_u32 s26, s26, 1
    s_cmp_lt_u32 s26, 14
    s_cbranch_scc1 L_concat_g1_A
    s_cmp_eq_u32 s16, 3
    s_cbranch_scc0 L_concat_ec_n0A
    s_lshl_b32 s29, s83, 7
    s_lshl_b32 s30, s57, 4
    s_add_u32 s29, s29, s30
    v_and_b32 v207, 15, v255
    buffer_load_ubyte v206, v207, s[52:55], s29 offen sc1
L_concat_ec_n0A:
    s_cmp_eq_u32 s16, 1
    s_cbranch_scc0 L_concat_ec_n1A
    s_mov_b32 s29, s19
    v_and_b32 v208, 7, v255
    v_lshlrev_b32 v208, 4, v208
    buffer_load_ubyte v205, v208, s[52:55], s29 offen sc1
L_concat_ec_n1A:
    s_mov_b32 s8, s84
    s_mov_b32 s9, s85
    s_mov_b32 s10, 2097152
    s_mov_b32 s11, 0x00020000
    v_lshrrev_b32 v188, 3, v255
    v_and_b32 v189, 7, v255
    v_lshrrev_b32 v190, 5, v255
    v_bfe_u32 v191, v255, 4, 1
    v_lshl_or_b32 v190, v190, 1, v191
    v_lshlrev_b32 v190, 1, v190
    v_xor_b32 v189, v189, v190
    v_lshlrev_b32 v189, 4, v189
    v_lshl_add_u32 v188, v188, 11, v189
    s_lshl_b32 s29, s91, 7
    v_add_u32 v254, s29, v188
    s_and_b32 s88, s91, 3
    s_lshl_b32 s88, s88, 2
    s_lshr_b32 s29, s16, 2
    s_add_u32 s89, s29, s88
    s_add_u32 s89, s89, 6
    s_and_b32 s90, s16, 3
    s_lshl_b32 s90, s90, 14
    v_mfma_f32_16x16x32_bf16 v[0:3], v[128:131], v[96:99], v[0:3]
    ds_read_b64_tr_b16 v[152:153], v178 offset:12288
    v_mfma_f32_16x16x32_bf16 v[4:7], v[128:131], v[100:103], v[4:7]
    ds_read_b64_tr_b16 v[154:155], v178 offset:12800
    v_mfma_f32_16x16x32_bf16 v[8:11], v[128:131], v[104:107], v[8:11]
    ds_read_b128 v[112:115], v177 offset:0
    v_mfma_f32_16x16x32_bf16 v[12:15], v[128:131], v[108:111], v[12:15]
    ds_read_b128 v[116:119], v177 offset:2048
    v_mfma_f32_16x16x32_bf16 v[28:31], v[132:135], v[108:111], v[28:31]
    ds_read_b128 v[120:123], v177 offset:4096
    v_mfma_f32_16x16x32_bf16 v[24:27], v[132:135], v[104:107], v[24:27]
    ds_read_b128 v[124:127], v177 offset:6144
    v_mfma_f32_16x16x32_bf16 v[20:23], v[132:135], v[100:103], v[20:23]
    ds_read_b64_tr_b16 v[156:157], v179 offset:12288
    v_mfma_f32_16x16x32_bf16 v[16:19], v[132:135], v[96:99], v[16:19]
    ds_read_b64_tr_b16 v[158:159], v179 offset:12800
    v_mfma_f32_16x16x32_bf16 v[32:35], v[96:99], v[136:139], v[32:35]
    ds_read_b64_tr_b16 v[160:161], v178 offset:13312
    v_mfma_f32_16x16x32_bf16 v[48:51], v[96:99], v[140:143], v[48:51]
    ds_read_b64_tr_b16 v[162:163], v178 offset:13824
    v_mfma_f32_16x16x32_bf16 v[64:67], v[96:99], v[144:147], v[64:67]
    ds_read_b64_tr_b16 v[164:165], v179 offset:13312
    v_mfma_f32_16x16x32_bf16 v[80:83], v[96:99], v[148:151], v[80:83]
    ds_read_b64_tr_b16 v[166:167], v179 offset:13824
    v_mfma_f32_16x16x32_bf16 v[84:87], v[100:103], v[148:151], v[84:87]
    ds_read_b64_tr_b16 v[168:169], v178 offset:14336
    v_mfma_f32_16x16x32_bf16 v[68:71], v[100:103], v[144:147], v[68:71]
    ds_read_b64_tr_b16 v[170:171], v178 offset:14848
    v_mfma_f32_16x16x32_bf16 v[52:55], v[100:103], v[140:143], v[52:55]
    ds_read_b64_tr_b16 v[172:173], v179 offset:14336
    v_mfma_f32_16x16x32_bf16 v[36:39], v[100:103], v[136:139], v[36:39]
    ds_read_b64_tr_b16 v[174:175], v179 offset:14848
    v_mfma_f32_16x16x32_bf16 v[40:43], v[104:107], v[136:139], v[40:43]
    s_add_u32 s29, s22, 32768
    s_cmp_eq_u32 s29, 98304
    s_cselect_b32 s29, 0, s29
    s_sub_u32 s24, s29, s22
    s_lshl_b32 s30, s23, 1
    s_sub_u32 s25, 24576, s30
    v_mfma_f32_16x16x32_bf16 v[56:59], v[104:107], v[140:143], v[56:59]
    v_mfma_f32_16x16x32_bf16 v[72:75], v[104:107], v[144:147], v[72:75]
    v_add_u32 v176, s24, v176
    v_mfma_f32_16x16x32_bf16 v[88:91], v[104:107], v[148:151], v[88:91]
    v_add_u32 v177, s24, v177
    v_mfma_f32_16x16x32_bf16 v[92:95], v[108:111], v[148:151], v[92:95]
    v_add_u32 v178, s25, v178
    v_mfma_f32_16x16x32_bf16 v[76:79], v[108:111], v[144:147], v[76:79]
    v_add_u32 v179, s25, v179
    v_mfma_f32_16x16x32_bf16 v[60:63], v[108:111], v[140:143], v[60:63]
    v_mfma_f32_16x16x32_bf16 v[44:47], v[108:111], v[136:139], v[44:47]
    s_waitcnt vmcnt(0) lgkmcnt(0)
    s_barrier
    v_mfma_f32_16x16x32_bf16 v[0:3], v[152:155], v[112:115], v[0:3]
    ds_read_b64_tr_b16 v[128:129], v178 offset:0
    v_mfma_f32_16x16x32_bf16 v[4:7], v[152:155], v[116:119], v[4:7]
    ds_read_b64_tr_b16 v[130:131], v178 offset:512
    s_add_u32 s35, s89, 0
    s_and_b32 s35, s35, 15
    s_lshl_b32 s35, s35, 17
    s_add_u32 s35, s35, s90
    buffer_load_dwordx4 v[208:211], v254, s[8:11], s35 offen
    v_mfma_f32_16x16x32_bf16 v[8:11], v[152:155], v[120:123], v[8:11]
    ds_read_b128 v[96:99], v176 offset:0
    v_mfma_f32_16x16x32_bf16 v[12:15], v[152:155], v[124:127], v[12:15]
    ds_read_b128 v[100:103], v176 offset:2048
    s_add_u32 s35, s89, 2
    s_and_b32 s35, s35, 15
    s_lshl_b32 s35, s35, 17
    s_add_u32 s35, s35, s90
    buffer_load_dwordx4 v[212:215], v254, s[8:11], s35 offen
    v_mfma_f32_16x16x32_bf16 v[28:31], v[156:159], v[124:127], v[28:31]
    ds_read_b128 v[104:107], v176 offset:4096
    v_mfma_f32_16x16x32_bf16 v[24:27], v[156:159], v[120:123], v[24:27]
    ds_read_b128 v[108:111], v176 offset:6144
    s_add_u32 s35, s89, 4
    s_and_b32 s35, s35, 15
    s_lshl_b32 s35, s35, 17
    s_add_u32 s35, s35, s90
    buffer_load_dwordx4 v[216:219], v254, s[8:11], s35 offen
    v_mfma_f32_16x16x32_bf16 v[20:23], v[156:159], v[116:119], v[20:23]
    ds_read_b64_tr_b16 v[132:133], v179 offset:0
    v_mfma_f32_16x16x32_bf16 v[16:19], v[156:159], v[112:115], v[16:19]
    ds_read_b64_tr_b16 v[134:135], v179 offset:512
    s_add_u32 s35, s89, 6
    s_and_b32 s35, s35, 15
    s_lshl_b32 s35, s35, 17
    s_add_u32 s35, s35, s90
    buffer_load_dwordx4 v[220:223], v254, s[8:11], s35 offen
    v_mfma_f32_16x16x32_bf16 v[32:35], v[112:115], v[160:163], v[32:35]
    ds_read_b64_tr_b16 v[136:137], v178 offset:1024
    v_mfma_f32_16x16x32_bf16 v[48:51], v[112:115], v[164:167], v[48:51]
    ds_read_b64_tr_b16 v[138:139], v178 offset:1536
    v_mfma_f32_16x16x32_bf16 v[64:67], v[112:115], v[168:171], v[64:67]
    ds_read_b64_tr_b16 v[140:141], v179 offset:1024
    v_mfma_f32_16x16x32_bf16 v[80:83], v[112:115], v[172:175], v[80:83]
    ds_read_b64_tr_b16 v[142:143], v179 offset:1536
    v_mfma_f32_16x16x32_bf16 v[84:87], v[116:119], v[172:175], v[84:87]
    ds_read_b64_tr_b16 v[144:145], v178 offset:2048
    v_mfma_f32_16x16x32_bf16 v[68:71], v[116:119], v[168:171], v[68:71]
    ds_read_b64_tr_b16 v[146:147], v178 offset:2560
    v_mfma_f32_16x16x32_bf16 v[52:55], v[116:119], v[164:167], v[52:55]
    ds_read_b64_tr_b16 v[148:149], v179 offset:2048
    v_mfma_f32_16x16x32_bf16 v[36:39], v[116:119], v[160:163], v[36:39]
    ds_read_b64_tr_b16 v[150:151], v179 offset:2560
    v_mfma_f32_16x16x32_bf16 v[40:43], v[120:123], v[160:163], v[40:43]
    v_mfma_f32_16x16x32_bf16 v[56:59], v[120:123], v[164:167], v[56:59]
    v_mfma_f32_16x16x32_bf16 v[72:75], v[120:123], v[168:171], v[72:75]
    v_mfma_f32_16x16x32_bf16 v[88:91], v[120:123], v[172:175], v[88:91]
    v_mfma_f32_16x16x32_bf16 v[92:95], v[124:127], v[172:175], v[92:95]
    v_mfma_f32_16x16x32_bf16 v[76:79], v[124:127], v[168:171], v[76:79]
    v_mfma_f32_16x16x32_bf16 v[60:63], v[124:127], v[164:167], v[60:63]
    s_mov_b32 s51, s22
    v_mfma_f32_16x16x32_bf16 v[44:47], v[124:127], v[160:163], v[44:47]
    s_add_u32 s22, s22, s24
    s_add_u32 s23, s23, s25
    s_waitcnt lgkmcnt(0)
    v_mfma_f32_16x16x32_bf16 v[0:3], v[128:131], v[96:99], v[0:3]
    ds_read_b64_tr_b16 v[152:153], v178 offset:12288
    v_mfma_f32_16x16x32_bf16 v[4:7], v[128:131], v[100:103], v[4:7]
    ds_read_b64_tr_b16 v[154:155], v178 offset:12800
    s_add_u32 s35, s89, 8
    s_and_b32 s35, s35, 15
    s_lshl_b32 s35, s35, 17
    s_add_u32 s35, s35, s90
    buffer_load_dwordx4 v[224:227], v254, s[8:11], s35 offen
    v_mfma_f32_16x16x32_bf16 v[8:11], v[128:131], v[104:107], v[8:11]
    ds_read_b128 v[112:115], v177 offset:0
    v_mfma_f32_16x16x32_bf16 v[12:15], v[128:131], v[108:111], v[12:15]
    ds_read_b128 v[116:119], v177 offset:2048
    s_add_u32 s35, s89, 10
    s_and_b32 s35, s35, 15
    s_lshl_b32 s35, s35, 17
    s_add_u32 s35, s35, s90
    s_add_u32 s35, s35, 65536
    buffer_load_dwordx4 v[228:231], v254, s[8:11], s35 offen
    v_mfma_f32_16x16x32_bf16 v[28:31], v[132:135], v[108:111], v[28:31]
    ds_read_b128 v[120:123], v177 offset:4096
    v_mfma_f32_16x16x32_bf16 v[24:27], v[132:135], v[104:107], v[24:27]
    ds_read_b128 v[124:127], v177 offset:6144
    s_add_u32 s35, s89, 12
    s_and_b32 s35, s35, 15
    s_lshl_b32 s35, s35, 17
    s_add_u32 s35, s35, s90
    s_add_u32 s35, s35, 65536
    buffer_load_dwordx4 v[232:235], v254, s[8:11], s35 offen
    v_mfma_f32_16x16x32_bf16 v[20:23], v[132:135], v[100:103], v[20:23]
    ds_read_b64_tr_b16 v[156:157], v179 offset:12288
    v_mfma_f32_16x16x32_bf16 v[16:19], v[132:135], v[96:99], v[16:19]
    ds_read_b64_tr_b16 v[158:159], v179 offset:12800
    s_add_u32 s35, s89, 14
    s_and_b32 s35, s35, 15
    s_lshl_b32 s35, s35, 17
    s_add_u32 s35, s35, s90
    s_add_u32 s35, s35, 65536
    buffer_load_dwordx4 v[236:239], v254, s[8:11], s35 offen
    v_mfma_f32_16x16x32_bf16 v[32:35], v[96:99], v[136:139], v[32:35]
    ds_read_b64_tr_b16 v[160:161], v178 offset:13312
    v_mfma_f32_16x16x32_bf16 v[48:51], v[96:99], v[140:143], v[48:51]
    ds_read_b64_tr_b16 v[162:163], v178 offset:13824
    v_mfma_f32_16x16x32_bf16 v[64:67], v[96:99], v[144:147], v[64:67]
    ds_read_b64_tr_b16 v[164:165], v179 offset:13312
    v_mfma_f32_16x16x32_bf16 v[80:83], v[96:99], v[148:151], v[80:83]
    ds_read_b64_tr_b16 v[166:167], v179 offset:13824
    v_mfma_f32_16x16x32_bf16 v[84:87], v[100:103], v[148:151], v[84:87]
    ds_read_b64_tr_b16 v[168:169], v178 offset:14336
    v_mfma_f32_16x16x32_bf16 v[68:71], v[100:103], v[144:147], v[68:71]
    ds_read_b64_tr_b16 v[170:171], v178 offset:14848
    v_mfma_f32_16x16x32_bf16 v[52:55], v[100:103], v[140:143], v[52:55]
    ds_read_b64_tr_b16 v[172:173], v179 offset:14336
    v_mfma_f32_16x16x32_bf16 v[36:39], v[100:103], v[136:139], v[36:39]
    ds_read_b64_tr_b16 v[174:175], v179 offset:14848
    v_mfma_f32_16x16x32_bf16 v[40:43], v[104:107], v[136:139], v[40:43]
    s_add_u32 s29, s22, 32768
    s_cmp_eq_u32 s29, 98304
    s_cselect_b32 s29, 0, s29
    s_sub_u32 s24, s29, s22
    s_lshl_b32 s30, s23, 1
    s_sub_u32 s25, 24576, s30
    v_mfma_f32_16x16x32_bf16 v[56:59], v[104:107], v[140:143], v[56:59]
    v_mfma_f32_16x16x32_bf16 v[72:75], v[104:107], v[144:147], v[72:75]
    v_add_u32 v176, s24, v176
    v_mfma_f32_16x16x32_bf16 v[88:91], v[104:107], v[148:151], v[88:91]
    v_add_u32 v177, s24, v177
    v_mfma_f32_16x16x32_bf16 v[92:95], v[108:111], v[148:151], v[92:95]
    v_add_u32 v178, s25, v178
    v_mfma_f32_16x16x32_bf16 v[76:79], v[108:111], v[144:147], v[76:79]
    v_add_u32 v179, s25, v179
    v_mfma_f32_16x16x32_bf16 v[60:63], v[108:111], v[140:143], v[60:63]
    v_mfma_f32_16x16x32_bf16 v[44:47], v[108:111], v[136:139], v[44:47]
    s_waitcnt lgkmcnt(0)
    s_barrier
    v_mfma_f32_16x16x32_bf16 v[0:3], v[152:155], v[112:115], v[0:3]
    v_mfma_f32_16x16x32_bf16 v[4:7], v[152:155], v[116:119], v[4:7]
    s_add_u32 s35, s89, 16
    s_and_b32 s35, s35, 15
    s_lshl_b32 s35, s35, 17
    s_add_u32 s35, s35, s90
    s_add_u32 s35, s35, 65536
    buffer_load_dwordx4 v[240:243], v254, s[8:11], s35 offen
    v_mfma_f32_16x16x32_bf16 v[8:11], v[152:155], v[120:123], v[8:11]
    v_mfma_f32_16x16x32_bf16 v[12:15], v[152:155], v[124:127], v[12:15]
    s_add_u32 s35, s89, 18
    s_and_b32 s35, s35, 15
    s_lshl_b32 s35, s35, 17
    s_add_u32 s35, s35, s90
    s_add_u32 s35, s35, 65536
    buffer_load_dwordx4 v[244:247], v254, s[8:11], s35 offen
    v_mfma_f32_16x16x32_bf16 v[28:31], v[156:159], v[124:127], v[28:31]
    v_mfma_f32_16x16x32_bf16 v[24:27], v[156:159], v[120:123], v[24:27]
    s_add_u32 s35, s89, 20
    s_and_b32 s35, s35, 15
    s_lshl_b32 s35, s35, 17
    s_add_u32 s35, s35, s90
    s_add_u32 s35, s35, 65536
    buffer_load_dwordx4 v[248:251], v254, s[8:11], s35 offen
    v_mfma_f32_16x16x32_bf16 v[20:23], v[156:159], v[116:119], v[20:23]
    v_mfma_f32_16x16x32_bf16 v[16:19], v[156:159], v[112:115], v[16:19]
    v_mfma_f32_16x16x32_bf16 v[32:35], v[112:115], v[160:163], v[32:35]
    v_mfma_f32_16x16x32_bf16 v[48:51], v[112:115], v[164:167], v[48:51]
    v_mfma_f32_16x16x32_bf16 v[64:67], v[112:115], v[168:171], v[64:67]
    v_mfma_f32_16x16x32_bf16 v[80:83], v[112:115], v[172:175], v[80:83]
    v_mfma_f32_16x16x32_bf16 v[84:87], v[116:119], v[172:175], v[84:87]
    v_mfma_f32_16x16x32_bf16 v[68:71], v[116:119], v[168:171], v[68:71]
    v_mfma_f32_16x16x32_bf16 v[52:55], v[116:119], v[164:167], v[52:55]
    v_mfma_f32_16x16x32_bf16 v[36:39], v[116:119], v[160:163], v[36:39]
    v_mfma_f32_16x16x32_bf16 v[40:43], v[120:123], v[160:163], v[40:43]
    v_mfma_f32_16x16x32_bf16 v[56:59], v[120:123], v[164:167], v[56:59]
    v_mfma_f32_16x16x32_bf16 v[72:75], v[120:123], v[168:171], v[72:75]
    v_mfma_f32_16x16x32_bf16 v[88:91], v[120:123], v[172:175], v[88:91]
    v_mfma_f32_16x16x32_bf16 v[92:95], v[124:127], v[172:175], v[92:95]
    v_mfma_f32_16x16x32_bf16 v[76:79], v[124:127], v[168:171], v[76:79]
    v_mfma_f32_16x16x32_bf16 v[60:63], v[124:127], v[164:167], v[60:63]
    s_mov_b32 s51, s22
    v_mfma_f32_16x16x32_bf16 v[44:47], v[124:127], v[160:163], v[44:47]
    s_add_u32 s22, s22, s24
    s_add_u32 s23, s23, s25
    s_mul_i32 s29, s16, 3
    s_add_u32 s29, s29, 0
    s_lshr_b32 s30, s29, 2
    s_add_u32 s30, s30, s88
    s_and_b32 s30, s30, 15
    s_lshl_b32 s30, s30, 17
    s_and_b32 s31, s29, 3
    s_lshl_b32 s31, s31, 14
    s_add_u32 s30, s30, s31
    s_lshl_b32 s29, s29, 10
    s_add_u32 m0, s29, 131072
    s_nop 0
    buffer_load_dwordx4 v254, s[8:11], s30 offen lds
    s_mul_i32 s29, s16, 3
    s_add_u32 s29, s29, 1
    s_lshr_b32 s30, s29, 2
    s_add_u32 s30, s30, s88
    s_and_b32 s30, s30, 15
    s_lshl_b32 s30, s30, 17
    s_and_b32 s31, s29, 3
    s_lshl_b32 s31, s31, 14
    s_add_u32 s30, s30, s31
    s_lshl_b32 s29, s29, 10
    s_add_u32 m0, s29, 131072
    s_nop 0
    buffer_load_dwordx4 v254, s[8:11], s30 offen lds
    s_mul_i32 s29, s16, 3
    s_add_u32 s29, s29, 2
    s_lshr_b32 s30, s29, 2
    s_add_u32 s30, s30, s88
    s_and_b32 s30, s30, 15
    s_lshl_b32 s30, s30, 17
    s_and_b32 s31, s29, 3
    s_lshl_b32 s31, s31, 14
    s_add_u32 s30, s30, s31
    s_lshl_b32 s29, s29, 10
    s_add_u32 m0, s29, 131072
    s_nop 0
    buffer_load_dwordx4 v254, s[8:11], s30 offen lds
    s_add_u32 s35, s89, 22
    s_and_b32 s35, s35, 15
    s_lshl_b32 s35, s35, 17
    s_add_u32 s35, s35, s90
    s_add_u32 s35, s35, 65536
    buffer_load_dwordx4 v[168:171], v254, s[8:11], s35 offen
    s_add_u32 s35, s89, 24
    s_and_b32 s35, s35, 15
    s_lshl_b32 s35, s35, 17
    s_add_u32 s35, s35, s90
    s_add_u32 s35, s35, 65536
    buffer_load_dwordx4 v[172:175], v254, s[8:11], s35 offen
    v_mov_b32 v190, 155648
    v_mov_b32 v191, 0
    s_cmp_lg_u32 s16, 0
    s_cbranch_scc1 L_concat_nzA
    ds_write_b32 v190, v191 offset:20
L_concat_nzA:
    s_mov_b32 s29, 0x3fb8aa3b
    s_mov_b32 s30, 0x358637bd
    v_mul_f32 v188, s29, v32
    v_mul_f32 v189, s29, v33
    v_mul_f32 v190, s29, v34
    v_mul_f32 v191, s29, v35
    v_mul_f32 v192, s29, v36
    v_mul_f32 v193, s29, v37
    v_mul_f32 v194, s29, v38
    v_mul_f32 v195, s29, v39
    v_exp_f32_e64 v188, v188 clamp
    v_exp_f32_e64 v189, v189 clamp
    v_exp_f32_e64 v190, v190 clamp
    v_exp_f32_e64 v191, v191 clamp
    v_exp_f32_e64 v192, v192 clamp
    v_exp_f32_e64 v193, v193 clamp
    v_exp_f32_e64 v194, v194 clamp
    v_exp_f32_e64 v195, v195 clamp
    v_max_f32 v32, 0, v32
    v_max_f32 v33, 0, v33
    v_max_f32 v34, 0, v34
    v_max_f32 v35, 0, v35
    v_max_f32 v36, 0, v36
    v_max_f32 v37, 0, v37
    v_max_f32 v38, 0, v38
    v_max_f32 v39, 0, v39
    v_add_f32 v188, s30, v188
    v_add_f32 v189, s30, v189
    v_add_f32 v190, s30, v190
    v_add_f32 v191, s30, v191
    v_add_f32 v192, s30, v192
    v_add_f32 v193, s30, v193
    v_add_f32 v194, s30, v194
    v_add_f32 v195, s30, v195
    v_add_f32 v32, v32, v188
    v_add_f32 v33, v33, v189
    v_add_f32 v34, v34, v190
    v_add_f32 v35, v35, v191
    v_add_f32 v36, v36, v192
    v_add_f32 v37, v37, v193
    v_add_f32 v38, v38, v194
    v_add_f32 v39, v39, v195
    v_mul_f32 v188, s29, v40
    v_mul_f32 v189, s29, v41
    v_mul_f32 v190, s29, v42
    v_mul_f32 v191, s29, v43
    v_mul_f32 v192, s29, v44
    v_mul_f32 v193, s29, v45
    v_mul_f32 v194, s29, v46
    v_mul_f32 v195, s29, v47
    v_exp_f32_e64 v188, v188 clamp
    v_exp_f32_e64 v189, v189 clamp
    v_exp_f32_e64 v190, v190 clamp
    v_exp_f32_e64 v191, v191 clamp
    v_exp_f32_e64 v192, v192 clamp
    v_exp_f32_e64 v193, v193 clamp
    v_exp_f32_e64 v194, v194 clamp
    v_exp_f32_e64 v195, v195 clamp
    v_max_f32 v40, 0, v40
    v_max_f32 v41, 0, v41
    v_max_f32 v42, 0, v42
    v_max_f32 v43, 0, v43
    v_max_f32 v44, 0, v44
    v_max_f32 v45, 0, v45
    v_max_f32 v46, 0, v46
    v_max_f32 v47, 0, v47
    v_add_f32 v188, s30, v188
    v_add_f32 v189, s30, v189
    v_add_f32 v190, s30, v190
    v_add_f32 v191, s30, v191
    v_add_f32 v192, s30, v192
    v_add_f32 v193, s30, v193
    v_add_f32 v194, s30, v194
    v_add_f32 v195, s30, v195
    v_add_f32 v40, v40, v188
    v_add_f32 v41, v41, v189
    v_add_f32 v42, v42, v190
    v_add_f32 v43, v43, v191
    v_add_f32 v44, v44, v192
    v_add_f32 v45, v45, v193
    v_add_f32 v46, v46, v194
    v_add_f32 v47, v47, v195
    v_mul_f32 v188, s29, v48
    v_mul_f32 v189, s29, v49
    v_mul_f32 v190, s29, v50
    v_mul_f32 v191, s29, v51
    v_mul_f32 v192, s29, v52
    v_mul_f32 v193, s29, v53
    v_mul_f32 v194, s29, v54
    v_mul_f32 v195, s29, v55
    v_exp_f32_e64 v188, v188 clamp
    v_exp_f32_e64 v189, v189 clamp
    v_exp_f32_e64 v190, v190 clamp
    v_exp_f32_e64 v191, v191 clamp
    v_exp_f32_e64 v192, v192 clamp
    v_exp_f32_e64 v193, v193 clamp
    v_exp_f32_e64 v194, v194 clamp
    v_exp_f32_e64 v195, v195 clamp
    v_max_f32 v48, 0, v48
    v_max_f32 v49, 0, v49
    v_max_f32 v50, 0, v50
    v_max_f32 v51, 0, v51
    v_max_f32 v52, 0, v52
    v_max_f32 v53, 0, v53
    v_max_f32 v54, 0, v54
    v_max_f32 v55, 0, v55
    v_add_f32 v188, s30, v188
    v_add_f32 v189, s30, v189
    v_add_f32 v190, s30, v190
    v_add_f32 v191, s30, v191
    v_add_f32 v192, s30, v192
    v_add_f32 v193, s30, v193
    v_add_f32 v194, s30, v194
    v_add_f32 v195, s30, v195
    v_add_f32 v48, v48, v188
    v_add_f32 v49, v49, v189
    v_add_f32 v50, v50, v190
    v_add_f32 v51, v51, v191
    v_add_f32 v52, v52, v192
    v_add_f32 v53, v53, v193
    v_add_f32 v54, v54, v194
    v_add_f32 v55, v55, v195
    v_mul_f32 v188, s29, v56
    v_mul_f32 v189, s29, v57
    v_mul_f32 v190, s29, v58
    v_mul_f32 v191, s29, v59
    v_mul_f32 v192, s29, v60
    v_mul_f32 v193, s29, v61
    v_mul_f32 v194, s29, v62
    v_mul_f32 v195, s29, v63
    v_exp_f32_e64 v188, v188 clamp
    v_exp_f32_e64 v189, v189 clamp
    v_exp_f32_e64 v190, v190 clamp
    v_exp_f32_e64 v191, v191 clamp
    v_exp_f32_e64 v192, v192 clamp
    v_exp_f32_e64 v193, v193 clamp
    v_exp_f32_e64 v194, v194 clamp
    v_exp_f32_e64 v195, v195 clamp
    v_max_f32 v56, 0, v56
    v_max_f32 v57, 0, v57
    v_max_f32 v58, 0, v58
    v_max_f32 v59, 0, v59
    v_max_f32 v60, 0, v60
    v_max_f32 v61, 0, v61
    v_max_f32 v62, 0, v62
    v_max_f32 v63, 0, v63
    v_add_f32 v188, s30, v188
    v_add_f32 v189, s30, v189
    v_add_f32 v190, s30, v190
    v_add_f32 v191, s30, v191
    v_add_f32 v192, s30, v192
    v_add_f32 v193, s30, v193
    v_add_f32 v194, s30, v194
    v_add_f32 v195, s30, v195
    v_add_f32 v56, v56, v188
    v_add_f32 v57, v57, v189
    v_add_f32 v58, v58, v190
    v_add_f32 v59, v59, v191
    v_add_f32 v60, v60, v192
    v_add_f32 v61, v61, v193
    v_add_f32 v62, v62, v194
    v_add_f32 v63, v63, v195
    v_cvt_pk_bf16_f32 v112, v32, v33
    v_cvt_pk_bf16_f32 v113, v34, v35
    v_cvt_pk_bf16_f32 v114, v36, v37
    v_cvt_pk_bf16_f32 v115, v38, v39
    v_cvt_pk_bf16_f32 v128, v64, v65
    v_cvt_pk_bf16_f32 v129, v66, v67
    v_cvt_pk_bf16_f32 v130, v68, v69
    v_cvt_pk_bf16_f32 v131, v70, v71
    v_cvt_pk_bf16_f32 v116, v48, v49
    v_cvt_pk_bf16_f32 v117, v50, v51
    v_cvt_pk_bf16_f32 v118, v52, v53
    v_cvt_pk_bf16_f32 v119, v54, v55
    v_cvt_pk_bf16_f32 v132, v80, v81
    v_cvt_pk_bf16_f32 v133, v82, v83
    v_cvt_pk_bf16_f32 v134, v84, v85
    v_cvt_pk_bf16_f32 v135, v86, v87
    v_cvt_pk_bf16_f32 v120, v40, v41
    v_cvt_pk_bf16_f32 v121, v42, v43
    v_cvt_pk_bf16_f32 v122, v44, v45
    v_cvt_pk_bf16_f32 v123, v46, v47
    v_cvt_pk_bf16_f32 v136, v72, v73
    v_cvt_pk_bf16_f32 v137, v74, v75
    v_cvt_pk_bf16_f32 v138, v76, v77
    v_cvt_pk_bf16_f32 v139, v78, v79
    v_cvt_pk_bf16_f32 v124, v56, v57
    v_cvt_pk_bf16_f32 v125, v58, v59
    v_cvt_pk_bf16_f32 v126, v60, v61
    v_cvt_pk_bf16_f32 v127, v62, v63
    v_cvt_pk_bf16_f32 v140, v88, v89
    v_cvt_pk_bf16_f32 v141, v90, v91
    v_cvt_pk_bf16_f32 v142, v92, v93
    v_cvt_pk_bf16_f32 v143, v94, v95
    v_mov_b32 v196, 0x3f803f80
    v_mov_b32 v197, 0x3f803f80
    v_mov_b32 v198, 0x3f803f80
    v_mov_b32 v199, 0x3f803f80
    v_mov_b32 v144, 0
    v_mov_b32 v145, 0
    v_mov_b32 v146, 0
    v_mov_b32 v147, 0
    v_mov_b32 v148, 0
    v_mov_b32 v149, 0
    v_mov_b32 v150, 0
    v_mov_b32 v151, 0
    v_mov_b32 v152, 0
    v_mov_b32 v153, 0
    v_mov_b32 v154, 0
    v_mov_b32 v155, 0
    v_mov_b32 v156, 0
    v_mov_b32 v157, 0
    v_mov_b32 v158, 0
    v_mov_b32 v159, 0
    v_mov_b32 v160, 0
    v_mov_b32 v161, 0
    v_mov_b32 v162, 0
    v_mov_b32 v163, 0
    v_mov_b32 v164, 0
    v_mov_b32 v165, 0
    v_mov_b32 v166, 0
    v_mov_b32 v167, 0
    v_mfma_f32_16x16x32_bf16 v[144:147], v[112:115], v[128:131], v[144:147]
    v_mfma_f32_16x16x32_bf16 v[148:151], v[112:115], v[132:135], v[148:151]
    v_mfma_f32_16x16x32_bf16 v[160:163], v[112:115], v[196:199], v[160:163]
    v_mfma_f32_16x16x32_bf16 v[152:155], v[116:119], v[128:131], v[152:155]
    v_mfma_f32_16x16x32_bf16 v[156:159], v[116:119], v[132:135], v[156:159]
    v_mfma_f32_16x16x32_bf16 v[164:167], v[116:119], v[196:199], v[164:167]
    v_mfma_f32_16x16x32_bf16 v[144:147], v[120:123], v[136:139], v[144:147]
    v_mfma_f32_16x16x32_bf16 v[148:151], v[120:123], v[140:143], v[148:151]
    v_mfma_f32_16x16x32_bf16 v[160:163], v[120:123], v[196:199], v[160:163]
    v_mfma_f32_16x16x32_bf16 v[152:155], v[124:127], v[136:139], v[152:155]
    v_mfma_f32_16x16x32_bf16 v[156:159], v[124:127], v[140:143], v[156:159]
    v_mfma_f32_16x16x32_bf16 v[164:167], v[124:127], v[196:199], v[164:167]
    v_lshlrev_b32 v188, 4, v255
    s_lshl_b32 s30, s16, 13
    v_add_u32 v189, s30, v188
    ds_write_b128 v189, v[144:147] offset:0
    ds_write_b128 v189, v[148:151] offset:1024
    s_nop 0
    ds_write_b128 v189, v[152:155] offset:2048
    ds_write_b128 v189, v[156:159] offset:3072
    ds_write_b128 v189, v[160:163] offset:4096
    ds_write_b128 v189, v[164:167] offset:5120
    s_waitcnt lgkmcnt(0)
    s_barrier
    s_lshl_b32 s30, s32, 15
    s_lshl_b32 s34, s33, 10
    s_add_u32 s30, s30, s34
    v_add_u32 v189, s30, v188
    s_and_b32 s35, s33, 1
    s_lshl_b32 s35, s35, 10
    s_lshl_b32 s30, s32, 15
    s_add_u32 s30, s30, s35
    v_add_u32 v190, s30, v188
    ds_read_b128 v[32:35], v189 offset:0
    ds_read_b128 v[36:39], v190 offset:4096
    ds_read_b128 v[40:43], v189 offset:8192
    ds_read_b128 v[44:47], v190 offset:12288
    ds_read_b128 v[48:51], v189 offset:16384
    ds_read_b128 v[52:55], v190 offset:20480
    ds_read_b128 v[56:59], v189 offset:24576
    ds_read_b128 v[60:63], v190 offset:28672
    s_waitcnt lgkmcnt(0)
    v_add_f32 v32, v32, v40
    v_add_f32 v48, v48, v56
    v_add_f32 v33, v33, v41
    v_add_f32 v49, v49, v57
    v_add_f32 v34, v34, v42
    v_add_f32 v50, v50, v58
    v_add_f32 v35, v35, v43
    v_add_f32 v51, v51, v59
    v_add_f32 v36, v36, v44
    v_add_f32 v52, v52, v60
    v_add_f32 v37, v37, v45
    v_add_f32 v53, v53, v61
    v_add_f32 v38, v38, v46
    v_add_f32 v54, v54, v62
    v_add_f32 v39, v39, v47
    v_add_f32 v55, v55, v63
    v_add_f32 v32, v32, v48
    v_add_f32 v33, v33, v49
    v_add_f32 v34, v34, v50
    v_add_f32 v35, v35, v51
    v_add_f32 v36, v36, v52
    v_add_f32 v37, v37, v53
    v_add_f32 v38, v38, v54
    v_add_f32 v39, v39, v55
    s_lshl_b32 s29, s19, 1
    s_add_u32 s29, s29, s32
    s_mov_b32 s34, s29
    s_lshl_b32 s30, s18, 5
    s_add_u32 s30, s30, s29
    s_lshl_b32 s31, s30, 12
    s_lshl_b32 s35, s33, 10
    s_add_u32 s31, s31, s35
    s_add_u32 s31, s31, 16777216
    buffer_store_dwordx4 v[32:35], v188, s[12:15], s31 offen sc1
    s_lshl_b32 s31, s30, 7
    s_and_b32 s35, s33, 1
    s_lshl_b32 s35, s35, 6
    s_add_u32 s31, s31, s35
    s_add_u32 s31, s31, 17825792
    v_lshrrev_b32 v189, 4, v255
    v_lshlrev_b32 v189, 4, v189
    v_and_b32 v190, 15, v255
    v_cmp_eq_u32 vcc, 0, v190
    s_nop 0
    s_and_saveexec_b64 s[36:37], vcc
    buffer_store_dwordx4 v[36:39], v189, s[12:15], s31 offen sc1
    s_mov_b64 exec, s[36:37]
    s_waitcnt vmcnt(0) lgkmcnt(0)
    s_barrier
    s_cmp_lg_u32 s16, 0
    s_cbranch_scc1 L_concat_pub_akv
    s_mov_b64 s[58:59], exec
    s_mov_b64 exec, 1
    s_and_b32 s29, s101, 3
    s_lshl_b32 s29, s29, 3
    s_lshl_b32 s29, 1, s29
    s_andn2_b32 s30, s101, 3
    v_mov_b32 v193, s29
    v_mov_b32 v194, 0
    buffer_atomic_or v193, v194, s[12:15], s30 offen
    s_mov_b64 exec, s[58:59]
L_concat_pub_akv:
    s_lshr_b32 s29, s16, 2
    s_lshl_b32 s29, s29, 12
    s_lshr_b32 s30, s90, 4
    s_add_u32 s29, s29, s30
    v_lshlrev_b32 v194, 4, v255
    v_add_u32 v194, s29, v194
    ds_write_b128 v194, v[208:211] offset:0
    ds_write_b128 v194, v[212:215] offset:8192
    ds_write_b128 v194, v[216:219] offset:16384
    ds_write_b128 v194, v[220:223] offset:24576
    ds_write_b128 v194, v[224:227] offset:32768
    ds_write_b128 v194, v[228:231] offset:40960
    ds_write_b128 v194, v[232:235] offset:49152
    ds_write_b128 v194, v[236:239] offset:57344
    v_add_u32 v194, 65536, v194
    ds_write_b128 v194, v[240:243] offset:0
    ds_write_b128 v194, v[244:247] offset:8192
    ds_write_b128 v194, v[248:251] offset:16384
    ds_write_b128 v194, v[168:171] offset:24576
    ds_write_b128 v194, v[172:175] offset:32768
    s_mov_b32 s29, 0x3fb8aa3b
    s_mov_b32 s30, 0x358637bd
    v_mul_f32 v188, s29, v0
    v_mul_f32 v189, s29, v1
    v_mul_f32 v190, s29, v2
    v_mul_f32 v191, s29, v3
    v_mul_f32 v192, s29, v4
    v_mul_f32 v193, s29, v5
    v_mul_f32 v194, s29, v6
    v_mul_f32 v195, s29, v7
    v_exp_f32_e64 v188, v188 clamp
    v_exp_f32_e64 v189, v189 clamp
    v_exp_f32_e64 v190, v190 clamp
    v_exp_f32_e64 v191, v191 clamp
    v_exp_f32_e64 v192, v192 clamp
    v_exp_f32_e64 v193, v193 clamp
    v_exp_f32_e64 v194, v194 clamp
    v_exp_f32_e64 v195, v195 clamp
    v_max_f32 v0, 0, v0
    v_max_f32 v1, 0, v1
    v_max_f32 v2, 0, v2
    v_max_f32 v3, 0, v3
    v_max_f32 v4, 0, v4
    v_max_f32 v5, 0, v5
    v_max_f32 v6, 0, v6
    v_max_f32 v7, 0, v7
    v_add_f32 v188, s30, v188
    v_add_f32 v189, s30, v189
    v_add_f32 v190, s30, v190
    v_add_f32 v191, s30, v191
    v_add_f32 v192, s30, v192
    v_add_f32 v193, s30, v193
    v_add_f32 v194, s30, v194
    v_add_f32 v195, s30, v195
    v_add_f32 v0, v0, v188
    v_add_f32 v1, v1, v189
    v_add_f32 v2, v2, v190
    v_add_f32 v3, v3, v191
    v_add_f32 v4, v4, v192
    v_add_f32 v5, v5, v193
    v_add_f32 v6, v6, v194
    v_add_f32 v7, v7, v195
    v_mul_f32 v188, s29, v8
    v_mul_f32 v189, s29, v9
    v_mul_f32 v190, s29, v10
    v_mul_f32 v191, s29, v11
    v_mul_f32 v192, s29, v12
    v_mul_f32 v193, s29, v13
    v_mul_f32 v194, s29, v14
    v_mul_f32 v195, s29, v15
    v_exp_f32_e64 v188, v188 clamp
    v_exp_f32_e64 v189, v189 clamp
    v_exp_f32_e64 v190, v190 clamp
    v_exp_f32_e64 v191, v191 clamp
    v_exp_f32_e64 v192, v192 clamp
    v_exp_f32_e64 v193, v193 clamp
    v_exp_f32_e64 v194, v194 clamp
    v_exp_f32_e64 v195, v195 clamp
    v_max_f32 v8, 0, v8
    v_max_f32 v9, 0, v9
    v_max_f32 v10, 0, v10
    v_max_f32 v11, 0, v11
    v_max_f32 v12, 0, v12
    v_max_f32 v13, 0, v13
    v_max_f32 v14, 0, v14
    v_max_f32 v15, 0, v15
    v_add_f32 v188, s30, v188
    v_add_f32 v189, s30, v189
    v_add_f32 v190, s30, v190
    v_add_f32 v191, s30, v191
    v_add_f32 v192, s30, v192
    v_add_f32 v193, s30, v193
    v_add_f32 v194, s30, v194
    v_add_f32 v195, s30, v195
    v_add_f32 v8, v8, v188
    v_add_f32 v9, v9, v189
    v_add_f32 v10, v10, v190
    v_add_f32 v11, v11, v191
    v_add_f32 v12, v12, v192
    v_add_f32 v13, v13, v193
    v_add_f32 v14, v14, v194
    v_add_f32 v15, v15, v195
    v_mul_f32 v188, s29, v16
    v_mul_f32 v189, s29, v17
    v_mul_f32 v190, s29, v18
    v_mul_f32 v191, s29, v19
    v_mul_f32 v192, s29, v20
    v_mul_f32 v193, s29, v21
    v_mul_f32 v194, s29, v22
    v_mul_f32 v195, s29, v23
    v_exp_f32_e64 v188, v188 clamp
    v_exp_f32_e64 v189, v189 clamp
    v_exp_f32_e64 v190, v190 clamp
    v_exp_f32_e64 v191, v191 clamp
    v_exp_f32_e64 v192, v192 clamp
    v_exp_f32_e64 v193, v193 clamp
    v_exp_f32_e64 v194, v194 clamp
    v_exp_f32_e64 v195, v195 clamp
    v_max_f32 v16, 0, v16
    v_max_f32 v17, 0, v17
    v_max_f32 v18, 0, v18
    v_max_f32 v19, 0, v19
    v_max_f32 v20, 0, v20
    v_max_f32 v21, 0, v21
    v_max_f32 v22, 0, v22
    v_max_f32 v23, 0, v23
    v_add_f32 v188, s30, v188
    v_add_f32 v189, s30, v189
    v_add_f32 v190, s30, v190
    v_add_f32 v191, s30, v191
    v_add_f32 v192, s30, v192
    v_add_f32 v193, s30, v193
    v_add_f32 v194, s30, v194
    v_add_f32 v195, s30, v195
    v_add_f32 v16, v16, v188
    v_add_f32 v17, v17, v189
    v_add_f32 v18, v18, v190
    v_add_f32 v19, v19, v191
    v_add_f32 v20, v20, v192
    v_add_f32 v21, v21, v193
    v_add_f32 v22, v22, v194
    v_add_f32 v23, v23, v195
    v_mul_f32 v188, s29, v24
    v_mul_f32 v189, s29, v25
    v_mul_f32 v190, s29, v26
    v_mul_f32 v191, s29, v27
    v_mul_f32 v192, s29, v28
    v_mul_f32 v193, s29, v29
    v_mul_f32 v194, s29, v30
    v_mul_f32 v195, s29, v31
    v_exp_f32_e64 v188, v188 clamp
    v_exp_f32_e64 v189, v189 clamp
    v_exp_f32_e64 v190, v190 clamp
    v_exp_f32_e64 v191, v191 clamp
    v_exp_f32_e64 v192, v192 clamp
    v_exp_f32_e64 v193, v193 clamp
    v_exp_f32_e64 v194, v194 clamp
    v_exp_f32_e64 v195, v195 clamp
    v_max_f32 v24, 0, v24
    v_max_f32 v25, 0, v25
    v_max_f32 v26, 0, v26
    v_max_f32 v27, 0, v27
    v_max_f32 v28, 0, v28
    v_max_f32 v29, 0, v29
    v_max_f32 v30, 0, v30
    v_max_f32 v31, 0, v31
    v_add_f32 v188, s30, v188
    v_add_f32 v189, s30, v189
    v_add_f32 v190, s30, v190
    v_add_f32 v191, s30, v191
    v_add_f32 v192, s30, v192
    v_add_f32 v193, s30, v193
    v_add_f32 v194, s30, v194
    v_add_f32 v195, s30, v195
    v_add_f32 v24, v24, v188
    v_add_f32 v25, v25, v189
    v_add_f32 v26, v26, v190
    v_add_f32 v27, v27, v191
    v_add_f32 v28, v28, v192
    v_add_f32 v29, v29, v193
    v_add_f32 v30, v30, v194
    v_add_f32 v31, v31, v195
    v_cvt_pk_bf16_f32 v96, v0, v1
    v_cvt_pk_bf16_f32 v97, v2, v3
    v_cvt_pk_bf16_f32 v98, v16, v17
    v_cvt_pk_bf16_f32 v99, v18, v19
    v_cvt_pk_bf16_f32 v100, v4, v5
    v_cvt_pk_bf16_f32 v101, v6, v7
    v_cvt_pk_bf16_f32 v102, v20, v21
    v_cvt_pk_bf16_f32 v103, v22, v23
    v_cvt_pk_bf16_f32 v104, v8, v9
    v_cvt_pk_bf16_f32 v105, v10, v11
    v_cvt_pk_bf16_f32 v106, v24, v25
    v_cvt_pk_bf16_f32 v107, v26, v27
    v_cvt_pk_bf16_f32 v108, v12, v13
    v_cvt_pk_bf16_f32 v109, v14, v15
    v_cvt_pk_bf16_f32 v110, v28, v29
    v_cvt_pk_bf16_f32 v111, v30, v31
    s_cmp_lg_u32 s16, 1
    s_cbranch_scc1 L_concat_pb_akv
    s_mov_b32 s99, 0
L_concat_chk_akv:
    v_cmp_le_u32 vcc, 1, v205
    s_nop 0
    s_cmp_eq_u64 vcc, exec
    s_cbranch_scc1 L_concat_chkd_akv
    s_mov_b32 s29, s19
    v_and_b32 v189, 7, v255
    v_lshlrev_b32 v189, 4, v189
    buffer_load_ubyte v205, v189, s[52:55], s29 offen sc1
    s_add_u32 s99, s99, 1
    s_waitcnt vmcnt(0)
    s_cmp_lt_u32 s99, 4194304
    s_cbranch_scc1 L_concat_chk_akv
L_concat_chkd_akv:
    s_lshl_b32 s29, s19, 7
    s_add_u32 s29, s29, 18352128
    v_and_b32 v189, 7, v255
    s_mov_b32 s99, 0
L_concat_poll_akv:
    buffer_load_ubyte v188, v189, s[12:15], s29 offen sc1
    s_add_u32 s99, s99, 1
    s_waitcnt vmcnt(0)
    v_cmp_eq_u32 vcc, 1, v188
    s_nop 0
    s_cmp_eq_u64 vcc, exec
    s_cbranch_scc1 L_concat_polld_akv
    s_cmp_ge_u32 s99, 4194304
    s_cbranch_scc1 L_concat_polld_akv
    s_branch L_concat_poll_akv
L_concat_polld_akv:
L_concat_pb_akv:
    s_barrier
    s_lshl_b32 s34, s19, 1
    s_add_u32 s34, s34, s32
    s_lshl_b32 s29, s34, 12
    s_lshl_b32 s30, s33, 10
    s_add_u32 s29, s29, s30
    s_add_u32 s29, s29, 16777216
    s_lshl_b32 s30, s34, 7
    s_and_b32 s31, s33, 1
    s_lshl_b32 s31, s31, 6
    s_add_u32 s30, s30, s31
    s_add_u32 s30, s30, 17825792
    v_lshlrev_b32 v189, 4, v255
    v_lshrrev_b32 v190, 4, v255
    v_lshlrev_b32 v190, 4, v190
    buffer_load_dwordx4 v[32:35], v189, s[12:15], s29 offen sc1
    s_add_u32 s29, s29, 131072
    buffer_load_dwordx4 v[36:39], v189, s[12:15], s29 offen sc1
    s_add_u32 s29, s29, 131072
    buffer_load_dwordx4 v[40:43], v189, s[12:15], s29 offen sc1
    s_add_u32 s29, s29, 131072
    buffer_load_dwordx4 v[44:47], v189, s[12:15], s29 offen sc1
    s_add_u32 s29, s29, 131072
    buffer_load_dwordx4 v[48:51], v189, s[12:15], s29 offen sc1
    s_add_u32 s29, s29, 131072
    buffer_load_dwordx4 v[52:55], v189, s[12:15], s29 offen sc1
    s_add_u32 s29, s29, 131072
    buffer_load_dwordx4 v[56:59], v189, s[12:15], s29 offen sc1
    s_add_u32 s29, s29, 131072
    buffer_load_dwordx4 v[60:63], v189, s[12:15], s29 offen sc1
    s_cmp_ge_u32 s33, 2
    s_cbranch_scc1 L_concat_noz
    buffer_load_dwordx4 v[64:67], v190, s[12:15], s30 offen sc1
    s_add_u32 s30, s30, 4096
    buffer_load_dwordx4 v[68:71], v190, s[12:15], s30 offen sc1
    s_add_u32 s30, s30, 4096
    buffer_load_dwordx4 v[72:75], v190, s[12:15], s30 offen sc1
    s_add_u32 s30, s30, 4096
    buffer_load_dwordx4 v[76:79], v190, s[12:15], s30 offen sc1
    s_add_u32 s30, s30, 4096
    buffer_load_dwordx4 v[80:83], v190, s[12:15], s30 offen sc1
    s_add_u32 s30, s30, 4096
    buffer_load_dwordx4 v[84:87], v190, s[12:15], s30 offen sc1
    s_add_u32 s30, s30, 4096
    buffer_load_dwordx4 v[88:91], v190, s[12:15], s30 offen sc1
    s_add_u32 s30, s30, 4096
    buffer_load_dwordx4 v[92:95], v190, s[12:15], s30 offen sc1
L_concat_noz:
    s_waitcnt vmcnt(0)
    v_add_f32 v32, v32, v48
    v_add_f32 v33, v33, v49
    v_add_f32 v34, v34, v50
    v_add_f32 v35, v35, v51
    v_add_f32 v36, v36, v52
    v_add_f32 v37, v37, v53
    v_add_f32 v38, v38, v54
    v_add_f32 v39, v39, v55
    v_add_f32 v40, v40, v56
    v_add_f32 v41, v41, v57
    v_add_f32 v42, v42, v58
    v_add_f32 v43, v43, v59
    v_add_f32 v44, v44, v60
    v_add_f32 v45, v45, v61
    v_add_f32 v46, v46, v62
    v_add_f32 v47, v47, v63
    v_add_f32 v32, v32, v40
    v_add_f32 v33, v33, v41
    v_add_f32 v34, v34, v42
    v_add_f32 v35, v35, v43
    v_add_f32 v36, v36, v44
    v_add_f32 v37, v37, v45
    v_add_f32 v38, v38, v46
    v_add_f32 v39, v39, v47
    v_add_f32 v32, v32, v36
    v_add_f32 v33, v33, v37
    v_add_f32 v34, v34, v38
    v_add_f32 v35, v35, v39
    v_add_f32 v64, v64, v80
    v_add_f32 v65, v65, v81
    v_add_f32 v66, v66, v82
    v_add_f32 v67, v67, v83
    v_add_f32 v68, v68, v84
    v_add_f32 v69, v69, v85
    v_add_f32 v70, v70, v86
    v_add_f32 v71, v71, v87
    v_add_f32 v72, v72, v88
    v_add_f32 v73, v73, v89
    v_add_f32 v74, v74, v90
    v_add_f32 v75, v75, v91
    v_add_f32 v76, v76, v92
    v_add_f32 v77, v77, v93
    v_add_f32 v78, v78, v94
    v_add_f32 v79, v79, v95
    v_add_f32 v64, v64, v72
    v_add_f32 v65, v65, v73
    v_add_f32 v66, v66, v74
    v_add_f32 v67, v67, v75
    v_add_f32 v68, v68, v76
    v_add_f32 v69, v69, v77
    v_add_f32 v70, v70, v78
    v_add_f32 v71, v71, v79
    v_add_f32 v64, v64, v68
    v_add_f32 v65, v65, v69
    v_add_f32 v66, v66, v70
    v_add_f32 v67, v67, v71
    s_mul_i32 s29, s32, 6144
    s_add_u32 s29, s29, 106496
    s_lshl_b32 s30, s33, 10
    s_add_u32 s30, s30, s29
    v_add_u32 v191, s30, v189
    ds_write_b128 v191, v[32:35]
    s_cmp_ge_u32 s33, 2
    s_cbranch_scc1 L_concat_nozw
    ds_write_b128 v191, v[64:67] offset:4096
L_concat_nozw:
    s_waitcnt lgkmcnt(0)
    s_barrier
    v_add_u32 v191, s29, v189
    ds_read_b128 v[0:3], v191 offset:0
    ds_read_b128 v[4:7], v191 offset:1024
    ds_read_b128 v[8:11], v191 offset:2048
    ds_read_b128 v[12:15], v191 offset:3072
    ds_read_b128 v[16:19], v191 offset:4096
    ds_read_b128 v[20:23], v191 offset:5120
    s_waitcnt lgkmcnt(0)
    v_cvt_pk_bf16_f32 v128, v0, v1
    v_cvt_pk_bf16_f32 v129, v2, v3
    v_cvt_pk_bf16_f32 v130, v8, v9
    v_cvt_pk_bf16_f32 v131, v10, v11
    v_cvt_pk_bf16_f32 v132, v4, v5
    v_cvt_pk_bf16_f32 v133, v6, v7
    v_cvt_pk_bf16_f32 v134, v12, v13
    v_cvt_pk_bf16_f32 v135, v14, v15
    v_cvt_pk_bf16_f32 v136, v16, v17
    v_cvt_pk_bf16_f32 v137, v18, v19
    v_cvt_pk_bf16_f32 v138, v20, v21
    v_cvt_pk_bf16_f32 v139, v22, v23
    v_mov_b32 v24, 0
    v_mov_b32 v25, 0
    v_mov_b32 v26, 0
    v_mov_b32 v27, 0
    s_nop 1
    v_mfma_f32_16x16x32_bf16 v[64:67], v[128:131], v[96:99], v[24:27]
    v_mfma_f32_16x16x32_bf16 v[68:71], v[128:131], v[100:103], v[24:27]
    v_mfma_f32_16x16x32_bf16 v[72:75], v[128:131], v[104:107], v[24:27]
    v_mfma_f32_16x16x32_bf16 v[76:79], v[128:131], v[108:111], v[24:27]
    v_mfma_f32_16x16x32_bf16 v[80:83], v[132:135], v[96:99], v[24:27]
    v_mfma_f32_16x16x32_bf16 v[84:87], v[132:135], v[100:103], v[24:27]
    v_mfma_f32_16x16x32_bf16 v[88:91], v[132:135], v[104:107], v[24:27]
    v_mfma_f32_16x16x32_bf16 v[92:95], v[132:135], v[108:111], v[24:27]
    v_mfma_f32_16x16x32_bf16 v[112:115], v[136:139], v[96:99], v[24:27]
    v_mfma_f32_16x16x32_bf16 v[116:119], v[136:139], v[100:103], v[24:27]
    v_mfma_f32_16x16x32_bf16 v[120:123], v[136:139], v[104:107], v[24:27]
    v_mfma_f32_16x16x32_bf16 v[124:127], v[136:139], v[108:111], v[24:27]
    s_mov_b32 s29, 0x358637bd
    s_nop 3
    v_add_f32 v112, s29, v112
    v_add_f32 v116, s29, v116
    v_add_f32 v120, s29, v120
    v_add_f32 v124, s29, v124
    v_rcp_f32 v188, v112
    v_rcp_f32 v189, v116
    v_rcp_f32 v190, v120
    v_rcp_f32 v191, v124
    v_mul_f32 v64, v188, v64
    v_mul_f32 v65, v188, v65
    v_mul_f32 v66, v188, v66
    v_mul_f32 v67, v188, v67
    v_mul_f32 v80, v188, v80
    v_mul_f32 v81, v188, v81
    v_mul_f32 v82, v188, v82
    v_mul_f32 v83, v188, v83
    v_mul_f32 v68, v189, v68
    v_mul_f32 v69, v189, v69
    v_mul_f32 v70, v189, v70
    v_mul_f32 v71, v189, v71
    v_mul_f32 v84, v189, v84
    v_mul_f32 v85, v189, v85
    v_mul_f32 v86, v189, v86
    v_mul_f32 v87, v189, v87
    v_mul_f32 v72, v190, v72
    v_mul_f32 v73, v190, v73
    v_mul_f32 v74, v190, v74
    v_mul_f32 v75, v190, v75
    v_mul_f32 v88, v190, v88
    v_mul_f32 v89, v190, v89
    v_mul_f32 v90, v190, v90
    v_mul_f32 v91, v190, v91
    v_mul_f32 v76, v191, v76
    v_mul_f32 v77, v191, v77
    v_mul_f32 v78, v191, v78
    v_mul_f32 v79, v191, v79
    v_mul_f32 v92, v191, v92
    v_mul_f32 v93, v191, v93
    v_mul_f32 v94, v191, v94
    v_mul_f32 v95, v191, v95
    v_cvt_pk_bf16_f32 v48, v64, v65
    v_cvt_pk_bf16_f32 v49, v66, v67
    v_cvt_pk_bf16_f32 v50, v80, v81
    v_cvt_pk_bf16_f32 v51, v82, v83
    v_cvt_pk_bf16_f32 v52, v68, v69
    v_cvt_pk_bf16_f32 v53, v70, v71
    v_cvt_pk_bf16_f32 v54, v84, v85
    v_cvt_pk_bf16_f32 v55, v86, v87
    v_cvt_pk_bf16_f32 v56, v72, v73
    v_cvt_pk_bf16_f32 v57, v74, v75
    v_cvt_pk_bf16_f32 v58, v88, v89
    v_cvt_pk_bf16_f32 v59, v90, v91
    v_cvt_pk_bf16_f32 v60, v76, v77
    v_cvt_pk_bf16_f32 v61, v78, v79
    v_cvt_pk_bf16_f32 v62, v92, v93
    v_cvt_pk_bf16_f32 v63, v94, v95
    s_lshl_b32 s29, s17, 7
    s_lshl_b32 s30, s18, 4
    s_add_u32 s29, s29, s30
    s_lshl_b32 s30, s33, 2
    s_add_u32 s29, s29, s30
    s_lshl_b32 s29, s29, 5
    s_lshl_b32 s30, s32, 4
    s_add_u32 s29, s29, s30
    s_add_u32 s29, s29, s19
    s_lshl_b32 s29, s29, 10
    s_add_u32 s29, s29, 18874368
    v_lshlrev_b32 v188, 4, v255
    buffer_store_dwordx4 v[48:51], v188, s[12:15], s29 offen sc1
    s_add_u32 s29, s29, 32768
    buffer_store_dwordx4 v[52:55], v188, s[12:15], s29 offen sc1
    s_add_u32 s29, s29, 32768
    buffer_store_dwordx4 v[56:59], v188, s[12:15], s29 offen sc1
    s_add_u32 s29, s29, 32768
    buffer_store_dwordx4 v[60:63], v188, s[12:15], s29 offen sc1
    s_waitcnt vmcnt(0) lgkmcnt(0)
    s_barrier
    s_cmp_lg_u32 s16, 0
    s_cbranch_scc1 L_concat_pub_ao
    s_mov_b64 s[58:59], exec
    s_mov_b64 exec, 1
    s_and_b32 s29, s100, 3
    s_lshl_b32 s29, s29, 3
    s_lshl_b32 s29, 1, s29
    s_andn2_b32 s30, s100, 3
    v_mov_b32 v188, s29
    v_mov_b32 v189, 0
    buffer_atomic_or v188, v189, s[12:15], s30 offen
    buffer_atomic_or v188, v189, s[12:15], s30 offen offset:16
    s_mov_b64 exec, s[58:59]
L_concat_pub_ao:
    s_branch L_concat_g3
L_concat_probB:
    s_waitcnt vmcnt(11)
    s_barrier
    ds_read_b64_tr_b16 v[128:129], v178 offset:0
    ds_read_b64_tr_b16 v[130:131], v178 offset:512
    ds_read_b128 v[96:99], v176 offset:0
    ds_read_b128 v[100:103], v176 offset:2048
    ds_read_b128 v[104:107], v176 offset:4096
    ds_read_b128 v[108:111], v176 offset:6144
    ds_read_b64_tr_b16 v[132:133], v179 offset:0
    ds_read_b64_tr_b16 v[134:135], v179 offset:512
    ds_read_b64_tr_b16 v[136:137], v178 offset:1024
    ds_read_b64_tr_b16 v[138:139], v178 offset:1536
    ds_read_b64_tr_b16 v[140:141], v179 offset:1024
    ds_read_b64_tr_b16 v[142:143], v179 offset:1536
    ds_read_b64_tr_b16 v[144:145], v178 offset:2048
    ds_read_b64_tr_b16 v[146:147], v178 offset:2560
    ds_read_b64_tr_b16 v[148:149], v179 offset:2048
    ds_read_b64_tr_b16 v[150:151], v179 offset:2560
    s_waitcnt lgkmcnt(0)
    v_mfma_f32_16x16x32_bf16 v[0:3], v[128:131], v[96:99], 0
    ds_read_b64_tr_b16 v[152:153], v178 offset:12288
    v_mfma_f32_16x16x32_bf16 v[4:7], v[128:131], v[100:103], 0
    ds_read_b64_tr_b16 v[154:155], v178 offset:12800
    v_mfma_f32_16x16x32_bf16 v[8:11], v[128:131], v[104:107], 0
    ds_read_b128 v[112:115], v177 offset:0
    v_mfma_f32_16x16x32_bf16 v[12:15], v[128:131], v[108:111], 0
    ds_read_b128 v[116:119], v177 offset:2048
    v_mfma_f32_16x16x32_bf16 v[28:31], v[132:135], v[108:111], 0
    ds_read_b128 v[120:123], v177 offset:4096
    v_mfma_f32_16x16x32_bf16 v[24:27], v[132:135], v[104:107], 0
    ds_read_b128 v[124:127], v177 offset:6144
    v_mfma_f32_16x16x32_bf16 v[20:23], v[132:135], v[100:103], 0
    ds_read_b64_tr_b16 v[156:157], v179 offset:12288
    v_mfma_f32_16x16x32_bf16 v[16:19], v[132:135], v[96:99], 0
    ds_read_b64_tr_b16 v[158:159], v179 offset:12800
    v_mfma_f32_16x16x32_bf16 v[32:35], v[136:139], v[96:99], 0
    ds_read_b64_tr_b16 v[160:161], v178 offset:13312
    v_mfma_f32_16x16x32_bf16 v[36:39], v[136:139], v[100:103], 0
    ds_read_b64_tr_b16 v[162:163], v178 offset:13824
    v_mfma_f32_16x16x32_bf16 v[40:43], v[136:139], v[104:107], 0
    ds_read_b64_tr_b16 v[164:165], v179 offset:13312
    v_mfma_f32_16x16x32_bf16 v[44:47], v[136:139], v[108:111], 0
    ds_read_b64_tr_b16 v[166:167], v179 offset:13824
    v_mfma_f32_16x16x32_bf16 v[60:63], v[140:143], v[108:111], 0
    ds_read_b64_tr_b16 v[168:169], v178 offset:14336
    v_mfma_f32_16x16x32_bf16 v[56:59], v[140:143], v[104:107], 0
    ds_read_b64_tr_b16 v[170:171], v178 offset:14848
    v_mfma_f32_16x16x32_bf16 v[52:55], v[140:143], v[100:103], 0
    ds_read_b64_tr_b16 v[172:173], v179 offset:14336
    v_mfma_f32_16x16x32_bf16 v[48:51], v[140:143], v[96:99], 0
    ds_read_b64_tr_b16 v[174:175], v179 offset:14848
    v_mfma_f32_16x16x32_bf16 v[64:67], v[96:99], v[144:147], 0
    s_add_u32 s29, s22, 32768
    s_cmp_eq_u32 s29, 98304
    s_cselect_b32 s29, 0, s29
    s_sub_u32 s24, s29, s22
    s_lshl_b32 s30, s23, 1
    s_sub_u32 s25, 24576, s30
    v_mfma_f32_16x16x32_bf16 v[80:83], v[96:99], v[148:151], 0
    v_mfma_f32_16x16x32_bf16 v[84:87], v[100:103], v[148:151], 0
    v_add_u32 v176, s24, v176
    v_mfma_f32_16x16x32_bf16 v[68:71], v[100:103], v[144:147], 0
    v_add_u32 v177, s24, v177
    v_mfma_f32_16x16x32_bf16 v[72:75], v[104:107], v[144:147], 0
    v_add_u32 v178, s25, v178
    v_mfma_f32_16x16x32_bf16 v[88:91], v[104:107], v[148:151], 0
    v_add_u32 v179, s25, v179
    v_mfma_f32_16x16x32_bf16 v[92:95], v[108:111], v[148:151], 0
    v_mfma_f32_16x16x32_bf16 v[76:79], v[108:111], v[144:147], 0
    s_waitcnt vmcnt(4) lgkmcnt(0)
    s_barrier
    v_mfma_f32_16x16x32_bf16 v[0:3], v[152:155], v[112:115], v[0:3]
    ds_read_b64_tr_b16 v[128:129], v178 offset:0
    s_add_u32 m0, s28, s23
    s_nop 0
    buffer_load_dwordx4 v184, s[8:11], s21 offen offset:0 lds
    v_mfma_f32_16x16x32_bf16 v[4:7], v[152:155], v[116:119], v[4:7]
    ds_read_b64_tr_b16 v[130:131], v178 offset:512
    v_mfma_f32_16x16x32_bf16 v[8:11], v[152:155], v[120:123], v[8:11]
    ds_read_b128 v[96:99], v176 offset:0
    buffer_load_dwordx4 v185, s[8:11], s21 offen offset:1024 lds
    v_mfma_f32_16x16x32_bf16 v[12:15], v[152:155], v[124:127], v[12:15]
    ds_read_b128 v[100:103], v176 offset:2048
    v_mfma_f32_16x16x32_bf16 v[28:31], v[156:159], v[124:127], v[28:31]
    ds_read_b128 v[104:107], v176 offset:4096
    buffer_load_dwordx4 v186, s[8:11], s21 offen offset:2048 lds
    v_mfma_f32_16x16x32_bf16 v[24:27], v[156:159], v[120:123], v[24:27]
    ds_read_b128 v[108:111], v176 offset:6144
    v_mfma_f32_16x16x32_bf16 v[20:23], v[156:159], v[116:119], v[20:23]
    ds_read_b64_tr_b16 v[132:133], v179 offset:0
    s_add_u32 s21, s21, 393216
    s_cmp_eq_u32 s21, 6291456
    s_cselect_b32 s21, 0, s21
    v_mfma_f32_16x16x32_bf16 v[16:19], v[156:159], v[112:115], v[16:19]
    ds_read_b64_tr_b16 v[134:135], v179 offset:512
    v_mfma_f32_16x16x32_bf16 v[32:35], v[160:163], v[112:115], v[32:35]
    ds_read_b64_tr_b16 v[136:137], v178 offset:1024
    v_mfma_f32_16x16x32_bf16 v[36:39], v[160:163], v[116:119], v[36:39]
    ds_read_b64_tr_b16 v[138:139], v178 offset:1536
    v_mfma_f32_16x16x32_bf16 v[40:43], v[160:163], v[120:123], v[40:43]
    ds_read_b64_tr_b16 v[140:141], v179 offset:1024
    v_mfma_f32_16x16x32_bf16 v[44:47], v[160:163], v[124:127], v[44:47]
    ds_read_b64_tr_b16 v[142:143], v179 offset:1536
    v_mfma_f32_16x16x32_bf16 v[60:63], v[164:167], v[124:127], v[60:63]
    ds_read_b64_tr_b16 v[144:145], v178 offset:2048
    v_mfma_f32_16x16x32_bf16 v[56:59], v[164:167], v[120:123], v[56:59]
    ds_read_b64_tr_b16 v[146:147], v178 offset:2560
    v_mfma_f32_16x16x32_bf16 v[52:55], v[164:167], v[116:119], v[52:55]
    ds_read_b64_tr_b16 v[148:149], v179 offset:2048
    v_mfma_f32_16x16x32_bf16 v[48:51], v[164:167], v[112:115], v[48:51]
    ds_read_b64_tr_b16 v[150:151], v179 offset:2560
    v_mfma_f32_16x16x32_bf16 v[64:67], v[112:115], v[168:171], v[64:67]
    v_mfma_f32_16x16x32_bf16 v[80:83], v[112:115], v[172:175], v[80:83]
    buffer_load_dword v204, v199, s[96:99], 0 offen
    v_mfma_f32_16x16x32_bf16 v[84:87], v[116:119], v[172:175], v[84:87]
    v_mfma_f32_16x16x32_bf16 v[68:71], v[116:119], v[168:171], v[68:71]
    v_mfma_f32_16x16x32_bf16 v[72:75], v[120:123], v[168:171], v[72:75]
    v_mfma_f32_16x16x32_bf16 v[88:91], v[120:123], v[172:175], v[88:91]
    v_mfma_f32_16x16x32_bf16 v[92:95], v[124:127], v[172:175], v[92:95]
    s_mov_b32 s51, s22
    v_mfma_f32_16x16x32_bf16 v[76:79], v[124:127], v[168:171], v[76:79]
    s_add_u32 s22, s22, s24
    s_add_u32 s23, s23, s25
    s_waitcnt lgkmcnt(0)
    s_mov_b32 s26, 1
    v_mfma_f32_16x16x32_bf16 v[0:3], v[128:131], v[96:99], v[0:3]
    ds_read_b64_tr_b16 v[152:153], v178 offset:12288
    v_mfma_f32_16x16x32_bf16 v[4:7], v[128:131], v[100:103], v[4:7]
    ds_read_b64_tr_b16 v[154:155], v178 offset:12800
    s_add_u32 m0, s27, s51
    s_nop 0
    buffer_load_dwordx4 v180, s[4:7], s20 offen offset:0 lds
    v_mfma_f32_16x16x32_bf16 v[8:11], v[128:131], v[104:107], v[8:11]
    ds_read_b128 v[112:115], v177 offset:0
    v_mfma_f32_16x16x32_bf16 v[12:15], v[128:131], v[108:111], v[12:15]
    ds_read_b128 v[116:119], v177 offset:2048
    v_mfma_f32_16x16x32_bf16 v[28:31], v[132:135], v[108:111], v[28:31]
    ds_read_b128 v[120:123], v177 offset:4096
    buffer_load_dwordx4 v181, s[4:7], s20 offen offset:1024 lds
    v_mfma_f32_16x16x32_bf16 v[24:27], v[132:135], v[104:107], v[24:27]
    ds_read_b128 v[124:127], v177 offset:6144
    v_mfma_f32_16x16x32_bf16 v[20:23], v[132:135], v[100:103], v[20:23]
    ds_read_b64_tr_b16 v[156:157], v179 offset:12288
    v_mfma_f32_16x16x32_bf16 v[16:19], v[132:135], v[96:99], v[16:19]
    ds_read_b64_tr_b16 v[158:159], v179 offset:12800
    buffer_load_dwordx4 v182, s[4:7], s20 offen offset:2048 lds
    v_mfma_f32_16x16x32_bf16 v[32:35], v[136:139], v[96:99], v[32:35]
    ds_read_b64_tr_b16 v[160:161], v178 offset:13312
    v_mfma_f32_16x16x32_bf16 v[36:39], v[136:139], v[100:103], v[36:39]
    ds_read_b64_tr_b16 v[162:163], v178 offset:13824
    v_mfma_f32_16x16x32_bf16 v[40:43], v[136:139], v[104:107], v[40:43]
    ds_read_b64_tr_b16 v[164:165], v179 offset:13312
    buffer_load_dwordx4 v183, s[4:7], s20 offen offset:3072 lds
    v_mfma_f32_16x16x32_bf16 v[44:47], v[136:139], v[108:111], v[44:47]
    ds_read_b64_tr_b16 v[166:167], v179 offset:13824
    v_mfma_f32_16x16x32_bf16 v[60:63], v[140:143], v[108:111], v[60:63]
    ds_read_b64_tr_b16 v[168:169], v178 offset:14336
    v_mfma_f32_16x16x32_bf16 v[56:59], v[140:143], v[104:107], v[56:59]
    ds_read_b64_tr_b16 v[170:171], v178 offset:14848
    s_add_u32 s20, s20, 128
    s_and_b32 s20, s20, 0x7ff
    v_mfma_f32_16x16x32_bf16 v[52:55], v[140:143], v[100:103], v[52:55]
    ds_read_b64_tr_b16 v[172:173], v179 offset:14336
    v_mfma_f32_16x16x32_bf16 v[48:51], v[140:143], v[96:99], v[48:51]
    ds_read_b64_tr_b16 v[174:175], v179 offset:14848
    v_mfma_f32_16x16x32_bf16 v[64:67], v[96:99], v[144:147], v[64:67]
    s_add_u32 s29, s22, 32768
    s_cmp_eq_u32 s29, 98304
    s_cselect_b32 s29, 0, s29
    s_sub_u32 s24, s29, s22
    s_lshl_b32 s30, s23, 1
    s_sub_u32 s25, 24576, s30
    v_mfma_f32_16x16x32_bf16 v[80:83], v[96:99], v[148:151], v[80:83]
    v_mfma_f32_16x16x32_bf16 v[84:87], v[100:103], v[148:151], v[84:87]
    v_add_u32 v176, s24, v176
    v_mfma_f32_16x16x32_bf16 v[68:71], v[100:103], v[144:147], v[68:71]
    v_add_u32 v177, s24, v177
    v_mfma_f32_16x16x32_bf16 v[72:75], v[104:107], v[144:147], v[72:75]
    v_add_u32 v178, s25, v178
    v_mfma_f32_16x16x32_bf16 v[88:91], v[104:107], v[148:151], v[88:91]
    v_add_u32 v179, s25, v179
    v_mfma_f32_16x16x32_bf16 v[92:95], v[108:111], v[148:151], v[92:95]
    v_mfma_f32_16x16x32_bf16 v[76:79], v[108:111], v[144:147], v[76:79]
    s_waitcnt vmcnt(5) lgkmcnt(0)
    s_barrier
    s_cmp_eq_u32 s26, 1
    s_cbranch_scc0 L_concat_annhB
    s_cmp_lg_u32 s16, 7
    s_cbranch_scc1 L_concat_ann_doneB
    s_mov_b64 s[58:59], exec
    s_mov_b64 exec, 1
    s_and_b32 s34, s56, 3
    s_lshl_b32 s34, s34, 3
    s_lshl_b32 s34, 1, s34
    s_andn2_b32 s35, s56, 3
    v_mov_b32 v205, s34
    v_mov_b32 v206, 0
    buffer_atomic_or v205, v206, s[52:55], s35 offen
    s_mov_b64 exec, s[58:59]
    s_nop 3
L_concat_ann_doneB:
L_concat_annhB:
    v_mfma_f32_16x16x32_bf16 v[0:3], v[152:155], v[112:115], v[0:3]
    ds_read_b64_tr_b16 v[128:129], v178 offset:0
    s_add_u32 m0, s28, s23
    s_nop 0
    buffer_load_dwordx4 v184, s[8:11], s21 offen offset:0 lds
    v_mfma_f32_16x16x32_bf16 v[4:7], v[152:155], v[116:119], v[4:7]
    ds_read_b64_tr_b16 v[130:131], v178 offset:512
    v_mfma_f32_16x16x32_bf16 v[8:11], v[152:155], v[120:123], v[8:11]
    ds_read_b128 v[96:99], v176 offset:0
    buffer_load_dwordx4 v185, s[8:11], s21 offen offset:1024 lds
    v_mfma_f32_16x16x32_bf16 v[12:15], v[152:155], v[124:127], v[12:15]
    ds_read_b128 v[100:103], v176 offset:2048
    v_mfma_f32_16x16x32_bf16 v[28:31], v[156:159], v[124:127], v[28:31]
    ds_read_b128 v[104:107], v176 offset:4096
    buffer_load_dwordx4 v186, s[8:11], s21 offen offset:2048 lds
    v_mfma_f32_16x16x32_bf16 v[24:27], v[156:159], v[120:123], v[24:27]
    ds_read_b128 v[108:111], v176 offset:6144
    v_mfma_f32_16x16x32_bf16 v[20:23], v[156:159], v[116:119], v[20:23]
    ds_read_b64_tr_b16 v[132:133], v179 offset:0
    s_add_u32 s21, s21, 393216
    s_cmp_eq_u32 s21, 6291456
    s_cselect_b32 s21, 0, s21
    v_mfma_f32_16x16x32_bf16 v[16:19], v[156:159], v[112:115], v[16:19]
    ds_read_b64_tr_b16 v[134:135], v179 offset:512
    v_mfma_f32_16x16x32_bf16 v[32:35], v[160:163], v[112:115], v[32:35]
    ds_read_b64_tr_b16 v[136:137], v178 offset:1024
    v_mfma_f32_16x16x32_bf16 v[36:39], v[160:163], v[116:119], v[36:39]
    ds_read_b64_tr_b16 v[138:139], v178 offset:1536
    v_mfma_f32_16x16x32_bf16 v[40:43], v[160:163], v[120:123], v[40:43]
    ds_read_b64_tr_b16 v[140:141], v179 offset:1024
    v_mfma_f32_16x16x32_bf16 v[44:47], v[160:163], v[124:127], v[44:47]
    ds_read_b64_tr_b16 v[142:143], v179 offset:1536
    v_mfma_f32_16x16x32_bf16 v[60:63], v[164:167], v[124:127], v[60:63]
    ds_read_b64_tr_b16 v[144:145], v178 offset:2048
    v_mfma_f32_16x16x32_bf16 v[56:59], v[164:167], v[120:123], v[56:59]
    ds_read_b64_tr_b16 v[146:147], v178 offset:2560
    v_mfma_f32_16x16x32_bf16 v[52:55], v[164:167], v[116:119], v[52:55]
    ds_read_b64_tr_b16 v[148:149], v179 offset:2048
    v_mfma_f32_16x16x32_bf16 v[48:51], v[164:167], v[112:115], v[48:51]
    ds_read_b64_tr_b16 v[150:151], v179 offset:2560
    v_mfma_f32_16x16x32_bf16 v[64:67], v[112:115], v[168:171], v[64:67]
    v_mfma_f32_16x16x32_bf16 v[80:83], v[112:115], v[172:175], v[80:83]
    v_mfma_f32_16x16x32_bf16 v[84:87], v[116:119], v[172:175], v[84:87]
    v_mfma_f32_16x16x32_bf16 v[68:71], v[116:119], v[168:171], v[68:71]
    v_mfma_f32_16x16x32_bf16 v[72:75], v[120:123], v[168:171], v[72:75]
    v_mfma_f32_16x16x32_bf16 v[88:91], v[120:123], v[172:175], v[88:91]
    v_mfma_f32_16x16x32_bf16 v[92:95], v[124:127], v[172:175], v[92:95]
    s_mov_b32 s51, s22
    v_mfma_f32_16x16x32_bf16 v[76:79], v[124:127], v[168:171], v[76:79]
    s_add_u32 s22, s22, s24
    s_add_u32 s23, s23, s25
    s_waitcnt lgkmcnt(0)
    s_mov_b32 s26, 2
L_concat_g1_B:
    v_mfma_f32_16x16x32_bf16 v[0:3], v[128:131], v[96:99], v[0:3]
    ds_read_b64_tr_b16 v[152:153], v178 offset:12288
    v_mfma_f32_16x16x32_bf16 v[4:7], v[128:131], v[100:103], v[4:7]
    ds_read_b64_tr_b16 v[154:155], v178 offset:12800
    s_add_u32 m0, s27, s51
    s_nop 0
    buffer_load_dwordx4 v180, s[4:7], s20 offen offset:0 lds
    v_mfma_f32_16x16x32_bf16 v[8:11], v[128:131], v[104:107], v[8:11]
    ds_read_b128 v[112:115], v177 offset:0
    v_mfma_f32_16x16x32_bf16 v[12:15], v[128:131], v[108:111], v[12:15]
    ds_read_b128 v[116:119], v177 offset:2048
    v_mfma_f32_16x16x32_bf16 v[28:31], v[132:135], v[108:111], v[28:31]
    ds_read_b128 v[120:123], v177 offset:4096
    buffer_load_dwordx4 v181, s[4:7], s20 offen offset:1024 lds
    v_mfma_f32_16x16x32_bf16 v[24:27], v[132:135], v[104:107], v[24:27]
    ds_read_b128 v[124:127], v177 offset:6144
    v_mfma_f32_16x16x32_bf16 v[20:23], v[132:135], v[100:103], v[20:23]
    ds_read_b64_tr_b16 v[156:157], v179 offset:12288
    v_mfma_f32_16x16x32_bf16 v[16:19], v[132:135], v[96:99], v[16:19]
    ds_read_b64_tr_b16 v[158:159], v179 offset:12800
    buffer_load_dwordx4 v182, s[4:7], s20 offen offset:2048 lds
    v_mfma_f32_16x16x32_bf16 v[32:35], v[136:139], v[96:99], v[32:35]
    ds_read_b64_tr_b16 v[160:161], v178 offset:13312
    v_mfma_f32_16x16x32_bf16 v[36:39], v[136:139], v[100:103], v[36:39]
    ds_read_b64_tr_b16 v[162:163], v178 offset:13824
    v_mfma_f32_16x16x32_bf16 v[40:43], v[136:139], v[104:107], v[40:43]
    ds_read_b64_tr_b16 v[164:165], v179 offset:13312
    buffer_load_dwordx4 v183, s[4:7], s20 offen offset:3072 lds
    v_mfma_f32_16x16x32_bf16 v[44:47], v[136:139], v[108:111], v[44:47]
    ds_read_b64_tr_b16 v[166:167], v179 offset:13824
    v_mfma_f32_16x16x32_bf16 v[60:63], v[140:143], v[108:111], v[60:63]
    ds_read_b64_tr_b16 v[168:169], v178 offset:14336
    v_mfma_f32_16x16x32_bf16 v[56:59], v[140:143], v[104:107], v[56:59]
    ds_read_b64_tr_b16 v[170:171], v178 offset:14848
    s_add_u32 s20, s20, 128
    s_and_b32 s20, s20, 0x7ff
    v_mfma_f32_16x16x32_bf16 v[52:55], v[140:143], v[100:103], v[52:55]
    ds_read_b64_tr_b16 v[172:173], v179 offset:14336
    v_mfma_f32_16x16x32_bf16 v[48:51], v[140:143], v[96:99], v[48:51]
    ds_read_b64_tr_b16 v[174:175], v179 offset:14848
    v_mfma_f32_16x16x32_bf16 v[64:67], v[96:99], v[144:147], v[64:67]
    s_add_u32 s29, s22, 32768
    s_cmp_eq_u32 s29, 98304
    s_cselect_b32 s29, 0, s29
    s_sub_u32 s24, s29, s22
    s_lshl_b32 s30, s23, 1
    s_sub_u32 s25, 24576, s30
    v_mfma_f32_16x16x32_bf16 v[80:83], v[96:99], v[148:151], v[80:83]
    v_mfma_f32_16x16x32_bf16 v[84:87], v[100:103], v[148:151], v[84:87]
    v_add_u32 v176, s24, v176
    v_mfma_f32_16x16x32_bf16 v[68:71], v[100:103], v[144:147], v[68:71]
    v_add_u32 v177, s24, v177
    v_mfma_f32_16x16x32_bf16 v[72:75], v[104:107], v[144:147], v[72:75]
    v_add_u32 v178, s25, v178
    v_mfma_f32_16x16x32_bf16 v[88:91], v[104:107], v[148:151], v[88:91]
    v_add_u32 v179, s25, v179
    v_mfma_f32_16x16x32_bf16 v[92:95], v[108:111], v[148:151], v[92:95]
    v_mfma_f32_16x16x32_bf16 v[76:79], v[108:111], v[144:147], v[76:79]
    s_waitcnt vmcnt(4) lgkmcnt(0)
    s_barrier
    v_mfma_f32_16x16x32_bf16 v[0:3], v[152:155], v[112:115], v[0:3]
    ds_read_b64_tr_b16 v[128:129], v178 offset:0
    s_add_u32 m0, s28, s23
    s_nop 0
    buffer_load_dwordx4 v184, s[8:11], s21 offen offset:0 lds
    v_mfma_f32_16x16x32_bf16 v[4:7], v[152:155], v[116:119], v[4:7]
    ds_read_b64_tr_b16 v[130:131], v178 offset:512
    v_mfma_f32_16x16x32_bf16 v[8:11], v[152:155], v[120:123], v[8:11]
    ds_read_b128 v[96:99], v176 offset:0
    buffer_load_dwordx4 v185, s[8:11], s21 offen offset:1024 lds
    v_mfma_f32_16x16x32_bf16 v[12:15], v[152:155], v[124:127], v[12:15]
    ds_read_b128 v[100:103], v176 offset:2048
    v_mfma_f32_16x16x32_bf16 v[28:31], v[156:159], v[124:127], v[28:31]
    ds_read_b128 v[104:107], v176 offset:4096
    buffer_load_dwordx4 v186, s[8:11], s21 offen offset:2048 lds
    v_mfma_f32_16x16x32_bf16 v[24:27], v[156:159], v[120:123], v[24:27]
    ds_read_b128 v[108:111], v176 offset:6144
    v_mfma_f32_16x16x32_bf16 v[20:23], v[156:159], v[116:119], v[20:23]
    ds_read_b64_tr_b16 v[132:133], v179 offset:0
    s_add_u32 s21, s21, 393216
    s_cmp_eq_u32 s21, 6291456
    s_cselect_b32 s21, 0, s21
    v_mfma_f32_16x16x32_bf16 v[16:19], v[156:159], v[112:115], v[16:19]
    ds_read_b64_tr_b16 v[134:135], v179 offset:512
    v_mfma_f32_16x16x32_bf16 v[32:35], v[160:163], v[112:115], v[32:35]
    ds_read_b64_tr_b16 v[136:137], v178 offset:1024
    v_mfma_f32_16x16x32_bf16 v[36:39], v[160:163], v[116:119], v[36:39]
    ds_read_b64_tr_b16 v[138:139], v178 offset:1536
    v_mfma_f32_16x16x32_bf16 v[40:43], v[160:163], v[120:123], v[40:43]
    ds_read_b64_tr_b16 v[140:141], v179 offset:1024
    v_mfma_f32_16x16x32_bf16 v[44:47], v[160:163], v[124:127], v[44:47]
    ds_read_b64_tr_b16 v[142:143], v179 offset:1536
    v_mfma_f32_16x16x32_bf16 v[60:63], v[164:167], v[124:127], v[60:63]
    ds_read_b64_tr_b16 v[144:145], v178 offset:2048
    v_mfma_f32_16x16x32_bf16 v[56:59], v[164:167], v[120:123], v[56:59]
    ds_read_b64_tr_b16 v[146:147], v178 offset:2560
    v_mfma_f32_16x16x32_bf16 v[52:55], v[164:167], v[116:119], v[52:55]
    ds_read_b64_tr_b16 v[148:149], v179 offset:2048
    v_mfma_f32_16x16x32_bf16 v[48:51], v[164:167], v[112:115], v[48:51]
    ds_read_b64_tr_b16 v[150:151], v179 offset:2560
    v_mfma_f32_16x16x32_bf16 v[64:67], v[112:115], v[168:171], v[64:67]
    v_mfma_f32_16x16x32_bf16 v[80:83], v[112:115], v[172:175], v[80:83]
    v_mfma_f32_16x16x32_bf16 v[84:87], v[116:119], v[172:175], v[84:87]
    v_mfma_f32_16x16x32_bf16 v[68:71], v[116:119], v[168:171], v[68:71]
    v_mfma_f32_16x16x32_bf16 v[72:75], v[120:123], v[168:171], v[72:75]
    v_mfma_f32_16x16x32_bf16 v[88:91], v[120:123], v[172:175], v[88:91]
    v_mfma_f32_16x16x32_bf16 v[92:95], v[124:127], v[172:175], v[92:95]
    s_mov_b32 s51, s22
    v_mfma_f32_16x16x32_bf16 v[76:79], v[124:127], v[168:171], v[76:79]
    s_add_u32 s22, s22, s24
    s_add_u32 s23, s23, s25
    s_waitcnt lgkmcnt(0)
    s_add_u32 s26, s26, 1
    s_cmp_lt_u32 s26, 14
    s_cbranch_scc1 L_concat_g1_B
    s_cmp_eq_u32 s16, 3
    s_cbranch_scc0 L_concat_ec_n0B
    s_lshl_b32 s29, s83, 7
    s_lshl_b32 s30, s57, 4
    s_add_u32 s29, s29, s30
    v_and_b32 v207, 15, v255
    buffer_load_ubyte v206, v207, s[52:55], s29 offen sc1
L_concat_ec_n0B:
    s_cmp_eq_u32 s16, 1
    s_cbranch_scc0 L_concat_ec_n1B
L_concat_ec_n1B:
    s_cmp_eq_u32 s33, 0
    s_cbranch_scc0 L_concat_ec_n2B
    s_sub_u32 s29, s56, 16
    s_cmp_eq_u32 s18, 0
    s_cselect_b32 s29, s56, s29
    v_mov_b32 v208, 0
    buffer_load_ubyte v205, v208, s[52:55], s29 offen sc1
L_concat_ec_n2B:
    s_mov_b32 s8, s84
    s_mov_b32 s9, s85
    s_mov_b32 s10, 2097152
    s_mov_b32 s11, 0x00020000
    v_lshrrev_b32 v188, 3, v255
    v_and_b32 v189, 7, v255
    v_lshrrev_b32 v190, 5, v255
    v_bfe_u32 v191, v255, 4, 1
    v_lshl_or_b32 v190, v190, 1, v191
    v_lshlrev_b32 v190, 1, v190
    v_xor_b32 v189, v189, v190
    v_lshlrev_b32 v189, 4, v189
    v_lshl_add_u32 v188, v188, 11, v189
    s_lshl_b32 s29, s91, 7
    v_add_u32 v254, s29, v188
    s_and_b32 s88, s91, 3
    s_lshl_b32 s88, s88, 2
    s_lshr_b32 s29, s16, 2
    s_add_u32 s89, s29, s88
    s_add_u32 s89, s89, 6
    s_and_b32 s90, s16, 3
    s_lshl_b32 s90, s90, 14
    v_mfma_f32_16x16x32_bf16 v[0:3], v[128:131], v[96:99], v[0:3]
    ds_read_b64_tr_b16 v[152:153], v178 offset:12288
    v_mfma_f32_16x16x32_bf16 v[4:7], v[128:131], v[100:103], v[4:7]
    ds_read_b64_tr_b16 v[154:155], v178 offset:12800
    v_mfma_f32_16x16x32_bf16 v[8:11], v[128:131], v[104:107], v[8:11]
    ds_read_b128 v[112:115], v177 offset:0
    v_mfma_f32_16x16x32_bf16 v[12:15], v[128:131], v[108:111], v[12:15]
    ds_read_b128 v[116:119], v177 offset:2048
    v_mfma_f32_16x16x32_bf16 v[28:31], v[132:135], v[108:111], v[28:31]
    ds_read_b128 v[120:123], v177 offset:4096
    v_mfma_f32_16x16x32_bf16 v[24:27], v[132:135], v[104:107], v[24:27]
    ds_read_b128 v[124:127], v177 offset:6144
    v_mfma_f32_16x16x32_bf16 v[20:23], v[132:135], v[100:103], v[20:23]
    ds_read_b64_tr_b16 v[156:157], v179 offset:12288
    v_mfma_f32_16x16x32_bf16 v[16:19], v[132:135], v[96:99], v[16:19]
    ds_read_b64_tr_b16 v[158:159], v179 offset:12800
    v_mfma_f32_16x16x32_bf16 v[32:35], v[136:139], v[96:99], v[32:35]
    ds_read_b64_tr_b16 v[160:161], v178 offset:13312
    v_mfma_f32_16x16x32_bf16 v[36:39], v[136:139], v[100:103], v[36:39]
    ds_read_b64_tr_b16 v[162:163], v178 offset:13824
    v_mfma_f32_16x16x32_bf16 v[40:43], v[136:139], v[104:107], v[40:43]
    ds_read_b64_tr_b16 v[164:165], v179 offset:13312
    v_mfma_f32_16x16x32_bf16 v[44:47], v[136:139], v[108:111], v[44:47]
    ds_read_b64_tr_b16 v[166:167], v179 offset:13824
    v_mfma_f32_16x16x32_bf16 v[60:63], v[140:143], v[108:111], v[60:63]
    ds_read_b64_tr_b16 v[168:169], v178 offset:14336
    v_mfma_f32_16x16x32_bf16 v[56:59], v[140:143], v[104:107], v[56:59]
    ds_read_b64_tr_b16 v[170:171], v178 offset:14848
    v_mfma_f32_16x16x32_bf16 v[52:55], v[140:143], v[100:103], v[52:55]
    ds_read_b64_tr_b16 v[172:173], v179 offset:14336
    v_mfma_f32_16x16x32_bf16 v[48:51], v[140:143], v[96:99], v[48:51]
    ds_read_b64_tr_b16 v[174:175], v179 offset:14848
    v_mfma_f32_16x16x32_bf16 v[64:67], v[96:99], v[144:147], v[64:67]
    s_add_u32 s29, s22, 32768
    s_cmp_eq_u32 s29, 98304
    s_cselect_b32 s29, 0, s29
    s_sub_u32 s24, s29, s22
    s_lshl_b32 s30, s23, 1
    s_sub_u32 s25, 24576, s30
    v_mfma_f32_16x16x32_bf16 v[80:83], v[96:99], v[148:151], v[80:83]
    v_mfma_f32_16x16x32_bf16 v[84:87], v[100:103], v[148:151], v[84:87]
    v_add_u32 v176, s24, v176
    v_mfma_f32_16x16x32_bf16 v[68:71], v[100:103], v[144:147], v[68:71]
    v_add_u32 v177, s24, v177
    v_mfma_f32_16x16x32_bf16 v[72:75], v[104:107], v[144:147], v[72:75]
    v_add_u32 v178, s25, v178
    v_mfma_f32_16x16x32_bf16 v[88:91], v[104:107], v[148:151], v[88:91]
    v_add_u32 v179, s25, v179
    v_mfma_f32_16x16x32_bf16 v[92:95], v[108:111], v[148:151], v[92:95]
    v_mfma_f32_16x16x32_bf16 v[76:79], v[108:111], v[144:147], v[76:79]
    s_waitcnt vmcnt(0) lgkmcnt(0)
    s_barrier
    v_mfma_f32_16x16x32_bf16 v[0:3], v[152:155], v[112:115], v[0:3]
    ds_read_b64_tr_b16 v[128:129], v178 offset:0
    v_mfma_f32_16x16x32_bf16 v[4:7], v[152:155], v[116:119], v[4:7]
    ds_read_b64_tr_b16 v[130:131], v178 offset:512
    s_add_u32 s35, s89, 0
    s_and_b32 s35, s35, 15
    s_lshl_b32 s35, s35, 17
    s_add_u32 s35, s35, s90
    buffer_load_dwordx4 v[208:211], v254, s[8:11], s35 offen
    v_mfma_f32_16x16x32_bf16 v[8:11], v[152:155], v[120:123], v[8:11]
    ds_read_b128 v[96:99], v176 offset:0
    v_mfma_f32_16x16x32_bf16 v[12:15], v[152:155], v[124:127], v[12:15]
    ds_read_b128 v[100:103], v176 offset:2048
    s_add_u32 s35, s89, 2
    s_and_b32 s35, s35, 15
    s_lshl_b32 s35, s35, 17
    s_add_u32 s35, s35, s90
    buffer_load_dwordx4 v[212:215], v254, s[8:11], s35 offen
    v_mfma_f32_16x16x32_bf16 v[28:31], v[156:159], v[124:127], v[28:31]
    ds_read_b128 v[104:107], v176 offset:4096
    v_mfma_f32_16x16x32_bf16 v[24:27], v[156:159], v[120:123], v[24:27]
    ds_read_b128 v[108:111], v176 offset:6144
    s_add_u32 s35, s89, 4
    s_and_b32 s35, s35, 15
    s_lshl_b32 s35, s35, 17
    s_add_u32 s35, s35, s90
    buffer_load_dwordx4 v[216:219], v254, s[8:11], s35 offen
    v_mfma_f32_16x16x32_bf16 v[20:23], v[156:159], v[116:119], v[20:23]
    ds_read_b64_tr_b16 v[132:133], v179 offset:0
    v_mfma_f32_16x16x32_bf16 v[16:19], v[156:159], v[112:115], v[16:19]
    ds_read_b64_tr_b16 v[134:135], v179 offset:512
    s_add_u32 s35, s89, 6
    s_and_b32 s35, s35, 15
    s_lshl_b32 s35, s35, 17
    s_add_u32 s35, s35, s90
    buffer_load_dwordx4 v[220:223], v254, s[8:11], s35 offen
    v_mfma_f32_16x16x32_bf16 v[32:35], v[160:163], v[112:115], v[32:35]
    ds_read_b64_tr_b16 v[136:137], v178 offset:1024
    v_mfma_f32_16x16x32_bf16 v[36:39], v[160:163], v[116:119], v[36:39]
    ds_read_b64_tr_b16 v[138:139], v178 offset:1536
    v_mfma_f32_16x16x32_bf16 v[40:43], v[160:163], v[120:123], v[40:43]
    ds_read_b64_tr_b16 v[140:141], v179 offset:1024
    v_mfma_f32_16x16x32_bf16 v[44:47], v[160:163], v[124:127], v[44:47]
    ds_read_b64_tr_b16 v[142:143], v179 offset:1536
    v_mfma_f32_16x16x32_bf16 v[60:63], v[164:167], v[124:127], v[60:63]
    ds_read_b64_tr_b16 v[144:145], v178 offset:2048
    v_mfma_f32_16x16x32_bf16 v[56:59], v[164:167], v[120:123], v[56:59]
    ds_read_b64_tr_b16 v[146:147], v178 offset:2560
    v_mfma_f32_16x16x32_bf16 v[52:55], v[164:167], v[116:119], v[52:55]
    ds_read_b64_tr_b16 v[148:149], v179 offset:2048
    v_mfma_f32_16x16x32_bf16 v[48:51], v[164:167], v[112:115], v[48:51]
    ds_read_b64_tr_b16 v[150:151], v179 offset:2560
    v_mfma_f32_16x16x32_bf16 v[64:67], v[112:115], v[168:171], v[64:67]
    v_mfma_f32_16x16x32_bf16 v[80:83], v[112:115], v[172:175], v[80:83]
    v_mfma_f32_16x16x32_bf16 v[84:87], v[116:119], v[172:175], v[84:87]
    v_mfma_f32_16x16x32_bf16 v[68:71], v[116:119], v[168:171], v[68:71]
    v_mfma_f32_16x16x32_bf16 v[72:75], v[120:123], v[168:171], v[72:75]
    v_mfma_f32_16x16x32_bf16 v[88:91], v[120:123], v[172:175], v[88:91]
    v_mfma_f32_16x16x32_bf16 v[92:95], v[124:127], v[172:175], v[92:95]
    s_mov_b32 s51, s22
    v_mfma_f32_16x16x32_bf16 v[76:79], v[124:127], v[168:171], v[76:79]
    s_add_u32 s22, s22, s24
    s_add_u32 s23, s23, s25
    s_waitcnt lgkmcnt(0)
    v_mfma_f32_16x16x32_bf16 v[0:3], v[128:131], v[96:99], v[0:3]
    ds_read_b64_tr_b16 v[152:153], v178 offset:12288
    v_mfma_f32_16x16x32_bf16 v[4:7], v[128:131], v[100:103], v[4:7]
    ds_read_b64_tr_b16 v[154:155], v178 offset:12800
    s_add_u32 s35, s89, 8
    s_and_b32 s35, s35, 15
    s_lshl_b32 s35, s35, 17
    s_add_u32 s35, s35, s90
    buffer_load_dwordx4 v[224:227], v254, s[8:11], s35 offen
    v_mfma_f32_16x16x32_bf16 v[8:11], v[128:131], v[104:107], v[8:11]
    ds_read_b128 v[112:115], v177 offset:0
    v_mfma_f32_16x16x32_bf16 v[12:15], v[128:131], v[108:111], v[12:15]
    ds_read_b128 v[116:119], v177 offset:2048
    s_add_u32 s35, s89, 10
    s_and_b32 s35, s35, 15
    s_lshl_b32 s35, s35, 17
    s_add_u32 s35, s35, s90
    s_add_u32 s35, s35, 65536
    buffer_load_dwordx4 v[228:231], v254, s[8:11], s35 offen
    v_mfma_f32_16x16x32_bf16 v[28:31], v[132:135], v[108:111], v[28:31]
    ds_read_b128 v[120:123], v177 offset:4096
    v_mfma_f32_16x16x32_bf16 v[24:27], v[132:135], v[104:107], v[24:27]
    ds_read_b128 v[124:127], v177 offset:6144
    s_add_u32 s35, s89, 12
    s_and_b32 s35, s35, 15
    s_lshl_b32 s35, s35, 17
    s_add_u32 s35, s35, s90
    s_add_u32 s35, s35, 65536
    buffer_load_dwordx4 v[232:235], v254, s[8:11], s35 offen
    v_mfma_f32_16x16x32_bf16 v[20:23], v[132:135], v[100:103], v[20:23]
    ds_read_b64_tr_b16 v[156:157], v179 offset:12288
    v_mfma_f32_16x16x32_bf16 v[16:19], v[132:135], v[96:99], v[16:19]
    ds_read_b64_tr_b16 v[158:159], v179 offset:12800
    s_add_u32 s35, s89, 14
    s_and_b32 s35, s35, 15
    s_lshl_b32 s35, s35, 17
    s_add_u32 s35, s35, s90
    s_add_u32 s35, s35, 65536
    buffer_load_dwordx4 v[236:239], v254, s[8:11], s35 offen
    v_mfma_f32_16x16x32_bf16 v[32:35], v[136:139], v[96:99], v[32:35]
    ds_read_b64_tr_b16 v[160:161], v178 offset:13312
    v_mfma_f32_16x16x32_bf16 v[36:39], v[136:139], v[100:103], v[36:39]
    ds_read_b64_tr_b16 v[162:163], v178 offset:13824
    v_mfma_f32_16x16x32_bf16 v[40:43], v[136:139], v[104:107], v[40:43]
    ds_read_b64_tr_b16 v[164:165], v179 offset:13312
    v_mfma_f32_16x16x32_bf16 v[44:47], v[136:139], v[108:111], v[44:47]
    ds_read_b64_tr_b16 v[166:167], v179 offset:13824
    v_mfma_f32_16x16x32_bf16 v[60:63], v[140:143], v[108:111], v[60:63]
    ds_read_b64_tr_b16 v[168:169], v178 offset:14336
    v_mfma_f32_16x16x32_bf16 v[56:59], v[140:143], v[104:107], v[56:59]
    ds_read_b64_tr_b16 v[170:171], v178 offset:14848
    v_mfma_f32_16x16x32_bf16 v[52:55], v[140:143], v[100:103], v[52:55]
    ds_read_b64_tr_b16 v[172:173], v179 offset:14336
    v_mfma_f32_16x16x32_bf16 v[48:51], v[140:143], v[96:99], v[48:51]
    ds_read_b64_tr_b16 v[174:175], v179 offset:14848
    v_mfma_f32_16x16x32_bf16 v[64:67], v[96:99], v[144:147], v[64:67]
    s_add_u32 s29, s22, 32768
    s_cmp_eq_u32 s29, 98304
    s_cselect_b32 s29, 0, s29
    s_sub_u32 s24, s29, s22
    s_lshl_b32 s30, s23, 1
    s_sub_u32 s25, 24576, s30
    v_mfma_f32_16x16x32_bf16 v[80:83], v[96:99], v[148:151], v[80:83]
    v_mfma_f32_16x16x32_bf16 v[84:87], v[100:103], v[148:151], v[84:87]
    v_add_u32 v176, s24, v176
    v_mfma_f32_16x16x32_bf16 v[68:71], v[100:103], v[144:147], v[68:71]
    v_add_u32 v177, s24, v177
    v_mfma_f32_16x16x32_bf16 v[72:75], v[104:107], v[144:147], v[72:75]
    v_add_u32 v178, s25, v178
    v_mfma_f32_16x16x32_bf16 v[88:91], v[104:107], v[148:151], v[88:91]
    v_add_u32 v179, s25, v179
    v_mfma_f32_16x16x32_bf16 v[92:95], v[108:111], v[148:151], v[92:95]
    v_mfma_f32_16x16x32_bf16 v[76:79], v[108:111], v[144:147], v[76:79]
    s_waitcnt lgkmcnt(0)
    s_barrier
    v_mfma_f32_16x16x32_bf16 v[0:3], v[152:155], v[112:115], v[0:3]
    v_mfma_f32_16x16x32_bf16 v[4:7], v[152:155], v[116:119], v[4:7]
    s_add_u32 s35, s89, 16
    s_and_b32 s35, s35, 15
    s_lshl_b32 s35, s35, 17
    s_add_u32 s35, s35, s90
    s_add_u32 s35, s35, 65536
    buffer_load_dwordx4 v[240:243], v254, s[8:11], s35 offen
    v_mfma_f32_16x16x32_bf16 v[8:11], v[152:155], v[120:123], v[8:11]
    v_mfma_f32_16x16x32_bf16 v[12:15], v[152:155], v[124:127], v[12:15]
    s_add_u32 s35, s89, 18
    s_and_b32 s35, s35, 15
    s_lshl_b32 s35, s35, 17
    s_add_u32 s35, s35, s90
    s_add_u32 s35, s35, 65536
    buffer_load_dwordx4 v[244:247], v254, s[8:11], s35 offen
    v_mfma_f32_16x16x32_bf16 v[28:31], v[156:159], v[124:127], v[28:31]
    v_mfma_f32_16x16x32_bf16 v[24:27], v[156:159], v[120:123], v[24:27]
    s_add_u32 s35, s89, 20
    s_and_b32 s35, s35, 15
    s_lshl_b32 s35, s35, 17
    s_add_u32 s35, s35, s90
    s_add_u32 s35, s35, 65536
    buffer_load_dwordx4 v[248:251], v254, s[8:11], s35 offen
    v_mfma_f32_16x16x32_bf16 v[20:23], v[156:159], v[116:119], v[20:23]
    v_mfma_f32_16x16x32_bf16 v[16:19], v[156:159], v[112:115], v[16:19]
    v_mfma_f32_16x16x32_bf16 v[32:35], v[160:163], v[112:115], v[32:35]
    v_mfma_f32_16x16x32_bf16 v[36:39], v[160:163], v[116:119], v[36:39]
    v_mfma_f32_16x16x32_bf16 v[40:43], v[160:163], v[120:123], v[40:43]
    v_mfma_f32_16x16x32_bf16 v[44:47], v[160:163], v[124:127], v[44:47]
    v_mfma_f32_16x16x32_bf16 v[60:63], v[164:167], v[124:127], v[60:63]
    v_mfma_f32_16x16x32_bf16 v[56:59], v[164:167], v[120:123], v[56:59]
    v_mfma_f32_16x16x32_bf16 v[52:55], v[164:167], v[116:119], v[52:55]
    v_mfma_f32_16x16x32_bf16 v[48:51], v[164:167], v[112:115], v[48:51]
    v_mfma_f32_16x16x32_bf16 v[64:67], v[112:115], v[168:171], v[64:67]
    v_mfma_f32_16x16x32_bf16 v[80:83], v[112:115], v[172:175], v[80:83]
    v_mfma_f32_16x16x32_bf16 v[84:87], v[116:119], v[172:175], v[84:87]
    v_mfma_f32_16x16x32_bf16 v[68:71], v[116:119], v[168:171], v[68:71]
    v_mfma_f32_16x16x32_bf16 v[72:75], v[120:123], v[168:171], v[72:75]
    v_mfma_f32_16x16x32_bf16 v[88:91], v[120:123], v[172:175], v[88:91]
    v_mfma_f32_16x16x32_bf16 v[92:95], v[124:127], v[172:175], v[92:95]
    s_mov_b32 s51, s22
    v_mfma_f32_16x16x32_bf16 v[76:79], v[124:127], v[168:171], v[76:79]
    s_add_u32 s22, s22, s24
    s_add_u32 s23, s23, s25
    v_cvt_pk_bf16_f32 v112, v32, v33
    v_cvt_pk_bf16_f32 v113, v34, v35
    v_cvt_pk_bf16_f32 v114, v48, v49
    v_cvt_pk_bf16_f32 v115, v50, v51
    v_cvt_pk_bf16_f32 v116, v36, v37
    v_cvt_pk_bf16_f32 v117, v38, v39
    v_cvt_pk_bf16_f32 v118, v52, v53
    v_cvt_pk_bf16_f32 v119, v54, v55
    v_cvt_pk_bf16_f32 v120, v40, v41
    v_cvt_pk_bf16_f32 v121, v42, v43
    v_cvt_pk_bf16_f32 v122, v56, v57
    v_cvt_pk_bf16_f32 v123, v58, v59
    v_cvt_pk_bf16_f32 v124, v44, v45
    v_cvt_pk_bf16_f32 v125, v46, v47
    v_cvt_pk_bf16_f32 v126, v60, v61
    v_cvt_pk_bf16_f32 v127, v62, v63
    v_cvt_pk_bf16_f32 v128, v64, v65
    v_cvt_pk_bf16_f32 v129, v66, v67
    v_cvt_pk_bf16_f32 v130, v68, v69
    v_cvt_pk_bf16_f32 v131, v70, v71
    v_cvt_pk_bf16_f32 v132, v80, v81
    v_cvt_pk_bf16_f32 v133, v82, v83
    v_cvt_pk_bf16_f32 v134, v84, v85
    v_cvt_pk_bf16_f32 v135, v86, v87
    v_cvt_pk_bf16_f32 v136, v72, v73
    v_cvt_pk_bf16_f32 v137, v74, v75
    v_cvt_pk_bf16_f32 v138, v76, v77
    v_cvt_pk_bf16_f32 v139, v78, v79
    v_cvt_pk_bf16_f32 v140, v88, v89
    v_cvt_pk_bf16_f32 v141, v90, v91
    v_cvt_pk_bf16_f32 v142, v92, v93
    v_cvt_pk_bf16_f32 v143, v94, v95
    v_lshlrev_b32 v189, 4, v255
    s_cmp_eq_u32 s18, 7
    s_cbranch_scc1 L_concat_nokv
    s_lshl_b32 s29, s19, 1
    s_add_u32 s29, s29, s32
    s_lshl_b32 s30, s29, 6
    s_lshl_b32 s31, s18, 3
    s_add_u32 s30, s30, s31
    s_lshl_b32 s31, s33, 1
    s_add_u32 s30, s30, s31
    s_lshl_b32 s30, s30, 12
    s_add_u32 s30, s30, 0
    buffer_store_dwordx4 v[112:115], v189, s[12:15], s30 offen offset:0 sc1
    buffer_store_dwordx4 v[116:119], v189, s[12:15], s30 offen offset:1024 sc1
    buffer_store_dwordx4 v[128:131], v189, s[12:15], s30 offen offset:2048 sc1
    buffer_store_dwordx4 v[132:135], v189, s[12:15], s30 offen offset:3072 sc1
    s_add_u32 s30, s30, 4096
    buffer_store_dwordx4 v[120:123], v189, s[12:15], s30 offen offset:0 sc1
    buffer_store_dwordx4 v[124:127], v189, s[12:15], s30 offen offset:1024 sc1
    buffer_store_dwordx4 v[136:139], v189, s[12:15], s30 offen offset:2048 sc1
    buffer_store_dwordx4 v[140:143], v189, s[12:15], s30 offen offset:3072 sc1
L_concat_nokv:
    s_lshl_b32 s29, s32, 16
    s_lshl_b32 s30, s33, 13
    s_add_u32 s29, s29, s30
    v_add_u32 v184, s29, v189
    ds_write_b128 v184, v[112:115] offset:32768
    ds_write_b128 v184, v[116:119] offset:33792
    ds_write_b128 v184, v[128:131] offset:34816
    ds_write_b128 v184, v[132:135] offset:35840
    ds_write_b128 v184, v[120:123] offset:36864
    ds_write_b128 v184, v[124:127] offset:37888
    ds_write_b128 v184, v[136:139] offset:38912
    ds_write_b128 v184, v[140:143] offset:39936
    v_mov_b32 v190, 155648
    v_mov_b32 v191, 0
    s_cmp_lg_u32 s16, 0
    s_cbranch_scc1 L_concat_nz
    ds_write_b32 v190, v191 offset:0
    ds_write_b32 v190, v191 offset:4
    ds_write_b32 v190, v191 offset:8
    ds_write_b32 v190, v191 offset:12
    ds_write_b32 v190, v191 offset:16
    ds_write_b32 v190, v191 offset:20
L_concat_nz:
    s_mov_b32 s29, 0x3e8293ee
    v_mul_f32 v0, s29, v0
    v_mul_f32 v1, s29, v1
    v_mul_f32 v2, s29, v2
    v_mul_f32 v3, s29, v3
    v_mul_f32 v4, s29, v4
    v_mul_f32 v5, s29, v5
    v_mul_f32 v6, s29, v6
    v_mul_f32 v7, s29, v7
    v_mul_f32 v8, s29, v8
    v_mul_f32 v9, s29, v9
    v_mul_f32 v10, s29, v10
    v_mul_f32 v11, s29, v11
    v_mul_f32 v12, s29, v12
    v_mul_f32 v13, s29, v13
    v_mul_f32 v14, s29, v14
    v_mul_f32 v15, s29, v15
    v_mul_f32 v16, s29, v16
    v_mul_f32 v17, s29, v17
    v_mul_f32 v18, s29, v18
    v_mul_f32 v19, s29, v19
    v_mul_f32 v20, s29, v20
    v_mul_f32 v21, s29, v21
    v_mul_f32 v22, s29, v22
    v_mul_f32 v23, s29, v23
    v_mul_f32 v24, s29, v24
    v_mul_f32 v25, s29, v25
    v_mul_f32 v26, s29, v26
    v_mul_f32 v27, s29, v27
    v_mul_f32 v28, s29, v28
    v_mul_f32 v29, s29, v29
    v_mul_f32 v30, s29, v30
    v_mul_f32 v31, s29, v31
    v_cvt_pk_bf16_f32 v96, v0, v1
    v_cvt_pk_bf16_f32 v97, v2, v3
    v_cvt_pk_bf16_f32 v98, v16, v17
    v_cvt_pk_bf16_f32 v99, v18, v19
    v_cvt_pk_bf16_f32 v100, v4, v5
    v_cvt_pk_bf16_f32 v101, v6, v7
    v_cvt_pk_bf16_f32 v102, v20, v21
    v_cvt_pk_bf16_f32 v103, v22, v23
    v_cvt_pk_bf16_f32 v104, v8, v9
    v_cvt_pk_bf16_f32 v105, v10, v11
    v_cvt_pk_bf16_f32 v106, v24, v25
    v_cvt_pk_bf16_f32 v107, v26, v27
    v_cvt_pk_bf16_f32 v108, v12, v13
    v_cvt_pk_bf16_f32 v109, v14, v15
    v_cvt_pk_bf16_f32 v110, v28, v29
    v_cvt_pk_bf16_f32 v111, v30, v31
    s_waitcnt lgkmcnt(0)
    s_barrier
    s_cmp_lg_u32 s33, 0
    s_cbranch_scc1 L_concat_nosig0
    s_cmp_eq_u32 s18, 7
    s_cbranch_scc1 L_concat_sig_doneL
    s_waitcnt vmcnt(0)
    v_mov_b32 v199, 155656
    v_mov_b32 v200, 1
    s_mov_b64 s[58:59], exec
    s_mov_b64 exec, 1
    ds_add_rtn_u32 v200, v199, v200
    s_waitcnt lgkmcnt(0)
    v_readfirstlane_b32 s29, v200
    s_mov_b64 exec, s[58:59]
    s_cmp_lg_u32 s29, 7
    s_cbranch_scc1 L_concat_sig_doneL
    s_mov_b64 s[58:59], exec
    s_mov_b64 exec, 1
    s_and_b32 s29, s101, 3
    s_lshl_b32 s29, s29, 3
    s_lshl_b32 s29, 1, s29
    s_andn2_b32 s30, s101, 3
    v_mov_b32 v199, s29
    v_mov_b32 v200, 0
    buffer_atomic_or v199, v200, s[12:15], s30 offen
    s_mov_b64 exec, s[58:59]
L_concat_sig_doneL:
L_concat_nosig0:
    s_lshl_b32 s49, s33, 1
    s_sub_u32 s49, 8, s49
    s_cmp_lg_u32 s33, 0
    s_cbranch_scc1 L_concat_noload
    s_cmp_eq_u32 s18, 0
    s_cbranch_scc1 L_concat_noload
    s_mov_b32 s99, 0
L_concat_chk_prev:
    v_cmp_le_u32 vcc, 1, v205
    s_nop 0
    s_cmp_eq_u64 vcc, exec
    s_cbranch_scc1 L_concat_chkd_prev
    s_sub_u32 s29, s56, 16
    s_cmp_eq_u32 s18, 0
    s_cselect_b32 s29, s56, s29
    v_mov_b32 v200, 0
    buffer_load_ubyte v205, v200, s[52:55], s29 offen sc1
    s_add_u32 s99, s99, 1
    s_waitcnt vmcnt(0)
    s_cmp_lt_u32 s99, 4194304
    s_cbranch_scc1 L_concat_chk_prev
L_concat_chkd_prev:
    s_sub_u32 s29, s101, 2048
    v_mov_b32 v200, 0
    s_mov_b32 s99, 0
L_concat_poll_prev:
    buffer_load_ubyte v199, v200, s[12:15], s29 offen sc1
    s_add_u32 s99, s99, 1
    s_waitcnt vmcnt(0)
    v_cmp_eq_u32 vcc, 1, v199
    s_nop 0
    s_cmp_eq_u64 vcc, exec
    s_cbranch_scc1 L_concat_polld_prev
    s_cmp_ge_u32 s99, 4194304
    s_cbranch_scc1 L_concat_polld_prev
    s_branch L_concat_poll_prev
L_concat_polld_prev:
    s_lshl_b32 s29, s19, 1
    s_add_u32 s29, s29, s32
    s_lshl_b32 s29, s29, 6
    s_lshl_b32 s30, s18, 3
    s_add_u32 s29, s29, s30
    s_sub_u32 s29, s29, 8
    s_lshl_b32 s29, s29, 12
    s_add_u32 s29, s29, 0
    s_lshl_b32 s30, s32, 16
    v_lshlrev_b32 v199, 4, v255
    s_add_u32 s29, s29, 28672
    s_add_u32 m0, s30, 28672
    s_nop 0
    buffer_load_dwordx4 v199, s[12:15], s29 offen offset:0 sc1 lds
    buffer_load_dwordx4 v199, s[12:15], s29 offen offset:1024 sc1 lds
    buffer_load_dwordx4 v199, s[12:15], s29 offen offset:2048 sc1 lds
    buffer_load_dwordx4 v199, s[12:15], s29 offen offset:3072 sc1 lds
    s_sub_u32 s29, s29, 4096
    s_add_u32 m0, s30, 24576
    s_nop 0
    buffer_load_dwordx4 v199, s[12:15], s29 offen offset:0 sc1 lds
    buffer_load_dwordx4 v199, s[12:15], s29 offen offset:1024 sc1 lds
    buffer_load_dwordx4 v199, s[12:15], s29 offen offset:2048 sc1 lds
    buffer_load_dwordx4 v199, s[12:15], s29 offen offset:3072 sc1 lds
    s_sub_u32 s29, s29, 4096
    s_add_u32 m0, s30, 20480
    s_nop 0
    buffer_load_dwordx4 v199, s[12:15], s29 offen offset:0 sc1 lds
    buffer_load_dwordx4 v199, s[12:15], s29 offen offset:1024 sc1 lds
    buffer_load_dwordx4 v199, s[12:15], s29 offen offset:2048 sc1 lds
    buffer_load_dwordx4 v199, s[12:15], s29 offen offset:3072 sc1 lds
    s_sub_u32 s29, s29, 4096
    s_add_u32 m0, s30, 16384
    s_nop 0
    buffer_load_dwordx4 v199, s[12:15], s29 offen offset:0 sc1 lds
    buffer_load_dwordx4 v199, s[12:15], s29 offen offset:1024 sc1 lds
    buffer_load_dwordx4 v199, s[12:15], s29 offen offset:2048 sc1 lds
    buffer_load_dwordx4 v199, s[12:15], s29 offen offset:3072 sc1 lds
    s_sub_u32 s29, s29, 4096
    s_add_u32 m0, s30, 12288
    s_nop 0
    buffer_load_dwordx4 v199, s[12:15], s29 offen offset:0 sc1 lds
    buffer_load_dwordx4 v199, s[12:15], s29 offen offset:1024 sc1 lds
    buffer_load_dwordx4 v199, s[12:15], s29 offen offset:2048 sc1 lds
    buffer_load_dwordx4 v199, s[12:15], s29 offen offset:3072 sc1 lds
    s_sub_u32 s29, s29, 4096
    s_add_u32 m0, s30, 8192
    s_nop 0
    buffer_load_dwordx4 v199, s[12:15], s29 offen offset:0 sc1 lds
    buffer_load_dwordx4 v199, s[12:15], s29 offen offset:1024 sc1 lds
    buffer_load_dwordx4 v199, s[12:15], s29 offen offset:2048 sc1 lds
    buffer_load_dwordx4 v199, s[12:15], s29 offen offset:3072 sc1 lds
    s_sub_u32 s29, s29, 4096
    s_add_u32 m0, s30, 4096
    s_nop 0
    buffer_load_dwordx4 v199, s[12:15], s29 offen offset:0 sc1 lds
    buffer_load_dwordx4 v199, s[12:15], s29 offen offset:1024 sc1 lds
    buffer_load_dwordx4 v199, s[12:15], s29 offen offset:2048 sc1 lds
    buffer_load_dwordx4 v199, s[12:15], s29 offen offset:3072 sc1 lds
    s_sub_u32 s29, s29, 4096
    s_add_u32 m0, s30, 0
    s_nop 0
    buffer_load_dwordx4 v199, s[12:15], s29 offen offset:0 sc1 lds
    buffer_load_dwordx4 v199, s[12:15], s29 offen offset:1024 sc1 lds
    buffer_load_dwordx4 v199, s[12:15], s29 offen offset:2048 sc1 lds
    buffer_load_dwordx4 v199, s[12:15], s29 offen offset:3072 sc1 lds
L_concat_noload:
    s_cmp_lg_u32 s33, 0
    s_cbranch_scc1 L_concat_ll
    s_mul_i32 s29, s16, 3
    s_add_u32 s29, s29, 0
    s_lshr_b32 s30, s29, 2
    s_add_u32 s30, s30, s88
    s_and_b32 s30, s30, 15
    s_lshl_b32 s30, s30, 17
    s_and_b32 s31, s29, 3
    s_lshl_b32 s31, s31, 14
    s_add_u32 s30, s30, s31
    s_lshl_b32 s29, s29, 10
    s_add_u32 m0, s29, 131072
    s_nop 0
    buffer_load_dwordx4 v254, s[8:11], s30 offen lds
    s_mul_i32 s29, s16, 3
    s_add_u32 s29, s29, 1
    s_lshr_b32 s30, s29, 2
    s_add_u32 s30, s30, s88
    s_and_b32 s30, s30, 15
    s_lshl_b32 s30, s30, 17
    s_and_b32 s31, s29, 3
    s_lshl_b32 s31, s31, 14
    s_add_u32 s30, s30, s31
    s_lshl_b32 s29, s29, 10
    s_add_u32 m0, s29, 131072
    s_nop 0
    buffer_load_dwordx4 v254, s[8:11], s30 offen lds
    s_mul_i32 s29, s16, 3
    s_add_u32 s29, s29, 2
    s_lshr_b32 s30, s29, 2
    s_add_u32 s30, s30, s88
    s_and_b32 s30, s30, 15
    s_lshl_b32 s30, s30, 17
    s_and_b32 s31, s29, 3
    s_lshl_b32 s31, s31, 14
    s_add_u32 s30, s30, s31
    s_lshl_b32 s29, s29, 10
    s_add_u32 m0, s29, 131072
    s_nop 0
    buffer_load_dwordx4 v254, s[8:11], s30 offen lds
    s_add_u32 s35, s89, 22
    s_and_b32 s35, s35, 15
    s_lshl_b32 s35, s35, 17
    s_add_u32 s35, s35, s90
    s_add_u32 s35, s35, 65536
    buffer_load_dwordx4 v[168:171], v254, s[8:11], s35 offen
    s_add_u32 s35, s89, 24
    s_and_b32 s35, s35, 15
    s_lshl_b32 s35, s35, 17
    s_add_u32 s35, s35, s90
    s_add_u32 s35, s35, 65536
    buffer_load_dwordx4 v[172:175], v254, s[8:11], s35 offen
L_concat_ll:
    v_and_b32 v188, 15, v255
    v_lshrrev_b32 v189, 4, v255
    v_lshlrev_b32 v189, 2, v189
    v_add_u32 v190, 0, v189
    v_cmp_le_u32 s[40:41], v190, v188
    v_add_u32 v190, 1, v189
    v_cmp_le_u32 s[42:43], v190, v188
    v_add_u32 v190, 2, v189
    v_cmp_le_u32 s[44:45], v190, v188
    v_add_u32 v190, 3, v189
    v_cmp_le_u32 s[46:47], v190, v188
    v_mov_b32 v176, 0x3f803f80
    v_mov_b32 v177, 0x3f803f80
    v_mov_b32 v178, 0x3f803f80
    v_mov_b32 v179, 0x3f803f80
    v_mov_b32 v196, 0xff800000
    v_mov_b32 v198, 0
    s_mov_b32 s51, 0x07060302
    s_mov_b32 s50, 0
    ds_read_b128 v[128:131], v184 offset:36864
    ds_read_b128 v[132:135], v184 offset:37888
    ds_read_b128 v[136:139], v184 offset:38912
    ds_read_b128 v[140:143], v184 offset:39936
    ds_read_b128 v[144:147], v184 offset:32768
    ds_read_b128 v[148:151], v184 offset:33792
    ds_read_b128 v[152:155], v184 offset:34816
    ds_read_b128 v[156:159], v184 offset:35840
    s_waitcnt lgkmcnt(0)
    v_cndmask_b32 v160, v196, v198, s[40:41]
    v_cndmask_b32 v161, v196, v198, s[42:43]
    v_cndmask_b32 v162, v196, v198, s[44:45]
    v_cndmask_b32 v163, v196, v198, s[46:47]
    s_nop 1
    v_mfma_f32_16x16x32_bf16 v[16:19], v[144:147], v[96:99], v[160:163]
    v_mfma_f32_16x16x32_bf16 v[20:23], v[148:151], v[100:103], v[160:163]
    v_mfma_f32_16x16x32_bf16 v[24:27], v[128:131], v[104:107], v[160:163]
    v_mfma_f32_16x16x32_bf16 v[28:31], v[132:135], v[108:111], v[160:163]
    s_nop 4
    v_max3_f32 v180, v16, v17, v18
    v_max_f32 v180, v180, v19
    v_max3_f32 v181, v20, v21, v22
    v_max_f32 v181, v181, v23
    v_max3_f32 v182, v24, v25, v26
    v_max_f32 v182, v182, v27
    v_max3_f32 v183, v28, v29, v30
    v_max_f32 v183, v183, v31
    v_mov_b32 v192, v180
    s_nop 1
    v_permlane32_swap_b32 v180, v192
    v_max_f32 v180, v180, v192
    v_mov_b32 v192, v180
    s_nop 1
    v_permlane16_swap_b32 v180, v192
    v_max_f32 v180, v180, v192
    v_mov_b32 v193, v181
    s_nop 1
    v_permlane32_swap_b32 v181, v193
    v_max_f32 v181, v181, v193
    v_mov_b32 v193, v181
    s_nop 1
    v_permlane16_swap_b32 v181, v193
    v_max_f32 v181, v181, v193
    v_mov_b32 v194, v182
    s_nop 1
    v_permlane32_swap_b32 v182, v194
    v_max_f32 v182, v182, v194
    v_mov_b32 v194, v182
    s_nop 1
    v_permlane16_swap_b32 v182, v194
    v_max_f32 v182, v182, v194
    v_mov_b32 v195, v183
    s_nop 1
    v_permlane32_swap_b32 v183, v195
    v_max_f32 v183, v183, v195
    v_mov_b32 v195, v183
    s_nop 1
    v_permlane16_swap_b32 v183, v195
    v_max_f32 v183, v183, v195
    v_sub_f32 v180, 0, v180
    v_sub_f32 v181, 0, v181
    v_sub_f32 v182, 0, v182
    v_sub_f32 v183, 0, v183
    s_cmp_eq_u32 s33, 0
    s_cbranch_scc1 L_concat_nosig1
    s_cmp_eq_u32 s18, 7
    s_cbranch_scc1 L_concat_sig_doneN
    s_waitcnt vmcnt(0)
    v_mov_b32 v199, 155656
    v_mov_b32 v200, 1
    s_mov_b64 s[58:59], exec
    s_mov_b64 exec, 1
    ds_add_rtn_u32 v200, v199, v200
    s_waitcnt lgkmcnt(0)
    v_readfirstlane_b32 s29, v200
    s_mov_b64 exec, s[58:59]
    s_cmp_lg_u32 s29, 7
    s_cbranch_scc1 L_concat_sig_doneN
    s_mov_b64 s[58:59], exec
    s_mov_b64 exec, 1
    s_and_b32 s29, s101, 3
    s_lshl_b32 s29, s29, 3
    s_lshl_b32 s29, 1, s29
    s_andn2_b32 s30, s101, 3
    v_mov_b32 v199, s29
    v_mov_b32 v200, 0
    buffer_atomic_or v199, v200, s[12:15], s30 offen
    s_mov_b64 exec, s[58:59]
L_concat_sig_doneN:
    s_mul_i32 s29, s16, 3
    s_add_u32 s29, s29, 0
    s_lshr_b32 s30, s29, 2
    s_add_u32 s30, s30, s88
    s_and_b32 s30, s30, 15
    s_lshl_b32 s30, s30, 17
    s_and_b32 s31, s29, 3
    s_lshl_b32 s31, s31, 14
    s_add_u32 s30, s30, s31
    s_lshl_b32 s29, s29, 10
    s_add_u32 m0, s29, 131072
    s_nop 0
    buffer_load_dwordx4 v254, s[8:11], s30 offen lds
    s_mul_i32 s29, s16, 3
    s_add_u32 s29, s29, 1
    s_lshr_b32 s30, s29, 2
    s_add_u32 s30, s30, s88
    s_and_b32 s30, s30, 15
    s_lshl_b32 s30, s30, 17
    s_and_b32 s31, s29, 3
    s_lshl_b32 s31, s31, 14
    s_add_u32 s30, s30, s31
    s_lshl_b32 s29, s29, 10
    s_add_u32 m0, s29, 131072
    s_nop 0
    buffer_load_dwordx4 v254, s[8:11], s30 offen lds
    s_mul_i32 s29, s16, 3
    s_add_u32 s29, s29, 2
    s_lshr_b32 s30, s29, 2
    s_add_u32 s30, s30, s88
    s_and_b32 s30, s30, 15
    s_lshl_b32 s30, s30, 17
    s_and_b32 s31, s29, 3
    s_lshl_b32 s31, s31, 14
    s_add_u32 s30, s30, s31
    s_lshl_b32 s29, s29, 10
    s_add_u32 m0, s29, 131072
    s_nop 0
    buffer_load_dwordx4 v254, s[8:11], s30 offen lds
    s_add_u32 s35, s89, 22
    s_and_b32 s35, s35, 15
    s_lshl_b32 s35, s35, 17
    s_add_u32 s35, s35, s90
    s_add_u32 s35, s35, 65536
    buffer_load_dwordx4 v[168:171], v254, s[8:11], s35 offen
    s_add_u32 s35, s89, 24
    s_and_b32 s35, s35, 15
    s_lshl_b32 s35, s35, 17
    s_add_u32 s35, s35, s90
    s_add_u32 s35, s35, 65536
    buffer_load_dwordx4 v[172:175], v254, s[8:11], s35 offen
L_concat_nosig1:
    s_branch L_concat_att_go
L_concat_att_pass:
    ds_read_b128 v[128:131], v184 offset:36864
    ds_read_b128 v[132:135], v184 offset:37888
    ds_read_b128 v[136:139], v184 offset:38912
    ds_read_b128 v[140:143], v184 offset:39936
    ds_read_b128 v[144:147], v184 offset:32768
    ds_read_b128 v[148:151], v184 offset:33792
    ds_read_b128 v[152:155], v184 offset:34816
    ds_read_b128 v[156:159], v184 offset:35840
    s_waitcnt lgkmcnt(0)
L_concat_att_go:
    v_mov_b32 v0, v180
    v_mov_b32 v1, v180
    v_mov_b32 v2, v180
    v_mov_b32 v3, v180
    v_mov_b32 v4, v181
    v_mov_b32 v5, v181
    v_mov_b32 v6, v181
    v_mov_b32 v7, v181
    v_mov_b32 v8, v182
    v_mov_b32 v9, v182
    v_mov_b32 v10, v182
    v_mov_b32 v11, v182
    v_mov_b32 v12, v183
    v_mov_b32 v13, v183
    v_mov_b32 v14, v183
    v_mov_b32 v15, v183
    v_cndmask_b32 v160, v196, v182, s[40:41]
    v_cndmask_b32 v161, v196, v182, s[42:43]
    v_cndmask_b32 v162, v196, v182, s[44:45]
    v_cndmask_b32 v163, v196, v182, s[46:47]
    v_cndmask_b32 v164, v196, v183, s[40:41]
    v_cndmask_b32 v165, v196, v183, s[42:43]
    v_cndmask_b32 v166, v196, v183, s[44:45]
    v_cndmask_b32 v167, v196, v183, s[46:47]
    v_mfma_f32_16x16x32_bf16 v[24:27], v[128:131], v[104:107], v[160:163]
    v_mfma_f32_16x16x32_bf16 v[28:31], v[128:131], v[108:111], v[12:15]
    v_mfma_f32_16x16x32_bf16 v[44:47], v[132:135], v[108:111], v[164:167]
    s_nop 5
    v_exp_f32 v24, v24
    v_exp_f32 v25, v25
    v_exp_f32 v26, v26
    v_exp_f32 v27, v27
    v_exp_f32 v28, v28
    v_exp_f32 v29, v29
    v_exp_f32 v30, v30
    v_exp_f32 v31, v31
    v_mov_b32 v58, 0
    v_mov_b32 v59, 0
    v_exp_f32 v44, v44
    v_exp_f32 v45, v45
    v_exp_f32 v46, v46
    v_exp_f32 v47, v47
    v_perm_b32 v56, v25, v24, s51
    v_perm_b32 v57, v27, v26, s51
    v_perm_b32 v60, v29, v28, s51
    v_perm_b32 v61, v31, v30, s51
    v_perm_b32 v62, v45, v44, s51
    v_perm_b32 v63, v47, v46, s51
    v_mfma_f32_16x16x32_bf16 v[72:75], v[136:139], v[56:59], 0
    s_nop 0
    v_mfma_f32_16x16x32_bf16 v[76:79], v[136:139], v[60:63], 0
    v_mfma_f32_16x16x32_bf16 v[88:91], v[140:143], v[56:59], 0
    v_mfma_f32_16x16x32_bf16 v[92:95], v[140:143], v[60:63], 0
    v_mfma_f32_16x16x32_bf16 v[120:123], v[176:179], v[56:59], 0
    v_mfma_f32_16x16x32_bf16 v[124:127], v[176:179], v[60:63], 0
    v_add_u32 v185, 28672, v184
    s_mov_b32 s48, 8
    s_cmp_lg_u32 s49, 8
    s_cbranch_scc1 L_concat_att_s8
    s_cmp_eq_u32 s18, 0
    s_cbranch_scc0 L_concat_att_s8w
    v_cndmask_b32 v160, v196, v180, s[40:41]
    v_cndmask_b32 v161, v196, v180, s[42:43]
    v_cndmask_b32 v162, v196, v180, s[44:45]
    v_cndmask_b32 v163, v196, v180, s[46:47]
    v_cndmask_b32 v164, v196, v181, s[40:41]
    v_cndmask_b32 v165, v196, v181, s[42:43]
    v_cndmask_b32 v166, v196, v181, s[44:45]
    v_cndmask_b32 v167, v196, v181, s[46:47]
    v_mfma_f32_16x16x32_bf16 v[16:19], v[144:147], v[96:99], v[160:163]
    v_mfma_f32_16x16x32_bf16 v[20:23], v[144:147], v[100:103], v[4:7]
    v_mfma_f32_16x16x32_bf16 v[24:27], v[144:147], v[104:107], v[8:11]
    v_mfma_f32_16x16x32_bf16 v[28:31], v[144:147], v[108:111], v[12:15]
    v_mfma_f32_16x16x32_bf16 v[36:39], v[148:151], v[100:103], v[164:167]
    v_mfma_f32_16x16x32_bf16 v[40:43], v[148:151], v[104:107], v[8:11]
    v_mfma_f32_16x16x32_bf16 v[44:47], v[148:151], v[108:111], v[12:15]
    s_nop 1
    v_exp_f32 v16, v16
    v_exp_f32 v17, v17
    v_exp_f32 v18, v18
    v_exp_f32 v19, v19
    v_exp_f32 v20, v20
    v_exp_f32 v21, v21
    v_exp_f32 v22, v22
    v_exp_f32 v23, v23
    v_exp_f32 v24, v24
    v_exp_f32 v25, v25
    v_exp_f32 v26, v26
    v_exp_f32 v27, v27
    v_exp_f32 v28, v28
    v_exp_f32 v29, v29
    v_exp_f32 v30, v30
    v_exp_f32 v31, v31
    v_mov_b32 v50, 0
    v_mov_b32 v51, 0
    v_exp_f32 v36, v36
    v_exp_f32 v37, v37
    v_exp_f32 v38, v38
    v_exp_f32 v39, v39
    v_exp_f32 v40, v40
    v_exp_f32 v41, v41
    v_exp_f32 v42, v42
    v_exp_f32 v43, v43
    v_exp_f32 v44, v44
    v_exp_f32 v45, v45
    v_exp_f32 v46, v46
    v_exp_f32 v47, v47
    v_perm_b32 v48, v17, v16, s51
    v_perm_b32 v49, v19, v18, s51
    v_perm_b32 v52, v21, v20, s51
    v_perm_b32 v53, v23, v22, s51
    v_perm_b32 v56, v25, v24, s51
    v_perm_b32 v57, v27, v26, s51
    v_perm_b32 v60, v29, v28, s51
    v_perm_b32 v61, v31, v30, s51
    v_perm_b32 v54, v37, v36, s51
    v_perm_b32 v55, v39, v38, s51
    v_perm_b32 v58, v41, v40, s51
    v_perm_b32 v59, v43, v42, s51
    v_perm_b32 v62, v45, v44, s51
    v_perm_b32 v63, v47, v46, s51
    v_mfma_f32_16x16x32_bf16 v[64:67], v[152:155], v[48:51], 0
    v_mfma_f32_16x16x32_bf16 v[68:71], v[152:155], v[52:55], 0
    v_mfma_f32_16x16x32_bf16 v[72:75], v[152:155], v[56:59], v[72:75]
    v_mfma_f32_16x16x32_bf16 v[76:79], v[152:155], v[60:63], v[76:79]
    v_mfma_f32_16x16x32_bf16 v[80:83], v[156:159], v[48:51], 0
    v_mfma_f32_16x16x32_bf16 v[84:87], v[156:159], v[52:55], 0
    v_mfma_f32_16x16x32_bf16 v[88:91], v[156:159], v[56:59], v[88:91]
    v_mfma_f32_16x16x32_bf16 v[92:95], v[156:159], v[60:63], v[92:95]
    v_mfma_f32_16x16x32_bf16 v[112:115], v[176:179], v[48:51], 0
    v_mfma_f32_16x16x32_bf16 v[116:119], v[176:179], v[52:55], 0
    v_mfma_f32_16x16x32_bf16 v[120:123], v[176:179], v[56:59], v[120:123]
    v_mfma_f32_16x16x32_bf16 v[124:127], v[176:179], v[60:63], v[124:127]
    s_branch L_concat_att_fin
L_concat_att_s8w:
    s_cmp_eq_u32 s50, 1
    s_cbranch_scc1 L_concat_att_s8
    s_cmp_lg_u32 s33, 0
    s_cbranch_scc1 L_concat_pw_w8
    s_waitcnt vmcnt(5)
    s_lshl_b32 s29, s32, 2
    s_add_u32 s29, s29, 155648
    v_mov_b32 v199, s29
    v_mov_b32 v200, 1
    ds_write_b32 v199, v200
    s_waitcnt lgkmcnt(0)
    s_branch L_concat_pd_w8
L_concat_pw_w8:
    s_lshl_b32 s29, s32, 2
    s_add_u32 s29, s29, 155648
    v_mov_b32 v199, s29
    s_mov_b32 s99, 0
L_concat_lw_w8:
    ds_read_b32 v200, v199
    s_add_u32 s99, s99, 1
    s_waitcnt lgkmcnt(0)
    v_readfirstlane_b32 s29, v200
    s_nop 0
    s_cmp_eq_u32 s29, 1
    s_cbranch_scc1 L_concat_pd_w8
    s_cmp_ge_u32 s99, 4194304
    s_cbranch_scc1 L_concat_pd_w8
    s_sleep 1
    s_branch L_concat_lw_w8
L_concat_pd_w8:
L_concat_att_s8:
    v_cndmask_b32 v160, v196, v180, s[40:41]
    v_cndmask_b32 v161, v196, v180, s[42:43]
    v_cndmask_b32 v162, v196, v180, s[44:45]
    v_cndmask_b32 v163, v196, v180, s[46:47]
    v_cndmask_b32 v164, v196, v181, s[40:41]
    v_cndmask_b32 v165, v196, v181, s[42:43]
    v_cndmask_b32 v166, v196, v181, s[44:45]
    v_cndmask_b32 v167, v196, v181, s[46:47]
    v_mfma_f32_16x16x32_bf16 v[16:19], v[144:147], v[96:99], v[160:163]
    ds_read_b128 v[128:131], v185 offset:0
    v_mfma_f32_16x16x32_bf16 v[20:23], v[144:147], v[100:103], v[4:7]
    ds_read_b128 v[132:135], v185 offset:1024
    v_mfma_f32_16x16x32_bf16 v[24:27], v[144:147], v[104:107], v[8:11]
    ds_read_b128 v[136:139], v185 offset:2048
    v_mfma_f32_16x16x32_bf16 v[28:31], v[144:147], v[108:111], v[12:15]
    ds_read_b128 v[140:143], v185 offset:3072
    v_mfma_f32_16x16x32_bf16 v[36:39], v[148:151], v[100:103], v[164:167]
    v_mfma_f32_16x16x32_bf16 v[40:43], v[148:151], v[104:107], v[8:11]
    v_mfma_f32_16x16x32_bf16 v[44:47], v[148:151], v[108:111], v[12:15]
    v_exp_f32 v16, v16
    v_exp_f32 v17, v17
    v_exp_f32 v18, v18
    v_exp_f32 v19, v19
    v_exp_f32 v20, v20
    v_exp_f32 v21, v21
    v_exp_f32 v22, v22
    v_exp_f32 v23, v23
    v_exp_f32 v24, v24
    v_exp_f32 v25, v25
    v_exp_f32 v26, v26
    v_exp_f32 v27, v27
    v_exp_f32 v28, v28
    v_exp_f32 v29, v29
    v_exp_f32 v30, v30
    v_exp_f32 v31, v31
    v_mov_b32 v50, 0
    v_mov_b32 v51, 0
    v_exp_f32 v36, v36
    v_exp_f32 v37, v37
    v_exp_f32 v38, v38
    v_exp_f32 v39, v39
    v_exp_f32 v40, v40
    v_exp_f32 v41, v41
    v_exp_f32 v42, v42
    v_exp_f32 v43, v43
    v_exp_f32 v44, v44
    v_exp_f32 v45, v45
    v_exp_f32 v46, v46
    v_exp_f32 v47, v47
    v_perm_b32 v48, v17, v16, s51
    v_perm_b32 v49, v19, v18, s51
    v_perm_b32 v52, v21, v20, s51
    v_perm_b32 v53, v23, v22, s51
    v_perm_b32 v56, v25, v24, s51
    v_perm_b32 v57, v27, v26, s51
    v_perm_b32 v60, v29, v28, s51
    v_perm_b32 v61, v31, v30, s51
    v_perm_b32 v54, v37, v36, s51
    v_perm_b32 v55, v39, v38, s51
    v_perm_b32 v58, v41, v40, s51
    v_perm_b32 v59, v43, v42, s51
    v_perm_b32 v62, v45, v44, s51
    v_perm_b32 v63, v47, v46, s51
    v_mfma_f32_16x16x32_bf16 v[64:67], v[152:155], v[48:51], 0
    v_mfma_f32_16x16x32_bf16 v[68:71], v[152:155], v[52:55], 0
    v_mfma_f32_16x16x32_bf16 v[72:75], v[152:155], v[56:59], v[72:75]
    v_mfma_f32_16x16x32_bf16 v[76:79], v[152:155], v[60:63], v[76:79]
    v_mfma_f32_16x16x32_bf16 v[80:83], v[156:159], v[48:51], 0
    v_mfma_f32_16x16x32_bf16 v[84:87], v[156:159], v[52:55], 0
    v_mfma_f32_16x16x32_bf16 v[88:91], v[156:159], v[56:59], v[88:91]
    v_mfma_f32_16x16x32_bf16 v[92:95], v[156:159], v[60:63], v[92:95]
    v_mfma_f32_16x16x32_bf16 v[112:115], v[176:179], v[48:51], 0
    v_mfma_f32_16x16x32_bf16 v[116:119], v[176:179], v[52:55], 0
    v_mfma_f32_16x16x32_bf16 v[120:123], v[176:179], v[56:59], v[120:123]
    v_mfma_f32_16x16x32_bf16 v[124:127], v[176:179], v[60:63], v[124:127]
    s_waitcnt lgkmcnt(0)
    v_add_u32 v201, 4294963200, v185
    ds_read_b128 v[144:147], v201 offset:0
    ds_read_b128 v[148:151], v201 offset:1024
    v_mfma_f32_16x16x32_bf16 v[16:19], v[128:131], v[96:99], v[0:3]
    v_mfma_f32_16x16x32_bf16 v[20:23], v[128:131], v[100:103], v[4:7]
    v_mfma_f32_16x16x32_bf16 v[32:35], v[132:135], v[96:99], v[0:3]
    v_mfma_f32_16x16x32_bf16 v[36:39], v[132:135], v[100:103], v[4:7]
    s_mov_b32 s48, 7
L_concat_att_loop:
    v_add_u32 v202, 4294959104, v185
    v_add_u32 v203, 4294955008, v185
    s_cmp_eq_u32 s48, 7
    s_cbranch_scc1 L_concat_att_A7
    v_mfma_f32_16x16x32_bf16 v[72:75], v[152:155], v[56:59], v[72:75]
    v_exp_f32 v16, v16
    v_exp_f32 v17, v17
    v_mfma_f32_16x16x32_bf16 v[76:79], v[152:155], v[60:63], v[76:79]
    v_exp_f32 v18, v18
    v_exp_f32 v19, v19
    v_mfma_f32_16x16x32_bf16 v[88:91], v[156:159], v[56:59], v[88:91]
    v_exp_f32 v20, v20
    v_exp_f32 v21, v21
    v_mfma_f32_16x16x32_bf16 v[92:95], v[156:159], v[60:63], v[92:95]
    v_exp_f32 v22, v22
    v_exp_f32 v23, v23
    v_mfma_f32_16x16x32_bf16 v[120:123], v[176:179], v[56:59], v[120:123]
    v_exp_f32 v32, v32
    v_exp_f32 v33, v33
    v_mfma_f32_16x16x32_bf16 v[124:127], v[176:179], v[60:63], v[124:127]
    v_exp_f32 v34, v34
    v_exp_f32 v35, v35
    v_mfma_f32_16x16x32_bf16 v[24:27], v[128:131], v[104:107], v[8:11]
    v_exp_f32 v36, v36
    v_exp_f32 v37, v37
    v_mfma_f32_16x16x32_bf16 v[28:31], v[128:131], v[108:111], v[12:15]
    v_exp_f32 v38, v38
    v_exp_f32 v39, v39
    v_mfma_f32_16x16x32_bf16 v[40:43], v[132:135], v[104:107], v[8:11]
    v_perm_b32 v48, v17, v16, s51
    v_perm_b32 v49, v19, v18, s51
    v_perm_b32 v52, v21, v20, s51
    v_perm_b32 v53, v23, v22, s51
    v_mfma_f32_16x16x32_bf16 v[44:47], v[132:135], v[108:111], v[12:15]
    v_perm_b32 v50, v33, v32, s51
    v_perm_b32 v51, v35, v34, s51
    v_perm_b32 v54, v37, v36, s51
    v_perm_b32 v55, v39, v38, s51
    s_branch L_concat_att_A7d
L_concat_att_A7:
    v_mfma_f32_16x16x32_bf16 v[24:27], v[128:131], v[104:107], v[8:11]
    v_exp_f32 v16, v16
    v_exp_f32 v17, v17
    v_mfma_f32_16x16x32_bf16 v[28:31], v[128:131], v[108:111], v[12:15]
    v_exp_f32 v18, v18
    v_exp_f32 v19, v19
    v_mfma_f32_16x16x32_bf16 v[40:43], v[132:135], v[104:107], v[8:11]
    v_exp_f32 v20, v20
    v_exp_f32 v21, v21
    v_mfma_f32_16x16x32_bf16 v[44:47], v[132:135], v[108:111], v[12:15]
    v_exp_f32 v22, v22
    v_exp_f32 v23, v23
    v_exp_f32 v32, v32
    v_exp_f32 v33, v33
    v_exp_f32 v34, v34
    v_exp_f32 v35, v35
    v_exp_f32 v36, v36
    v_exp_f32 v37, v37
    v_exp_f32 v38, v38
    v_exp_f32 v39, v39
    v_perm_b32 v48, v17, v16, s51
    v_perm_b32 v49, v19, v18, s51
    v_perm_b32 v52, v21, v20, s51
    v_perm_b32 v53, v23, v22, s51
    v_perm_b32 v50, v33, v32, s51
    v_perm_b32 v51, v35, v34, s51
    v_perm_b32 v54, v37, v36, s51
    v_perm_b32 v55, v39, v38, s51
L_concat_att_A7d:
    s_sub_u32 s29, s48, 1
    s_cmp_lg_u32 s29, s49
    s_cbranch_scc1 L_concat_att_nb
    s_cmp_eq_u32 s18, 0
    s_cbranch_scc1 L_concat_att_nb
    s_cmp_eq_u32 s50, 1
    s_cbranch_scc1 L_concat_att_nb
    s_cmp_lg_u32 s33, 0
    s_cbranch_scc1 L_concat_pw_wl
    s_waitcnt vmcnt(5)
    s_lshl_b32 s29, s32, 2
    s_add_u32 s29, s29, 155648
    v_mov_b32 v199, s29
    v_mov_b32 v200, 1
    ds_write_b32 v199, v200
    s_waitcnt lgkmcnt(0)
    s_branch L_concat_pd_wl
L_concat_pw_wl:
    s_lshl_b32 s29, s32, 2
    s_add_u32 s29, s29, 155648
    v_mov_b32 v199, s29
    s_mov_b32 s99, 0
L_concat_lw_wl:
    ds_read_b32 v200, v199
    s_add_u32 s99, s99, 1
    s_waitcnt lgkmcnt(0)
    v_readfirstlane_b32 s29, v200
    s_nop 0
    s_cmp_eq_u32 s29, 1
    s_cbranch_scc1 L_concat_pd_wl
    s_cmp_ge_u32 s99, 4194304
    s_cbranch_scc1 L_concat_pd_wl
    s_sleep 1
    s_branch L_concat_lw_wl
L_concat_pd_wl:
L_concat_att_nb:
    s_waitcnt lgkmcnt(0)
    v_mfma_f32_16x16x32_bf16 v[64:67], v[136:139], v[48:51], v[64:67]
    ds_read_b128 v[128:131], v202 offset:0
    v_exp_f32 v24, v24
    v_exp_f32 v25, v25
    v_mfma_f32_16x16x32_bf16 v[68:71], v[136:139], v[52:55], v[68:71]
    ds_read_b128 v[132:135], v202 offset:1024
    v_exp_f32 v26, v26
    v_exp_f32 v27, v27
    v_mfma_f32_16x16x32_bf16 v[80:83], v[140:143], v[48:51], v[80:83]
    ds_read_b128 v[152:155], v201 offset:2048
    v_exp_f32 v28, v28
    v_exp_f32 v29, v29
    v_mfma_f32_16x16x32_bf16 v[84:87], v[140:143], v[52:55], v[84:87]
    ds_read_b128 v[156:159], v201 offset:3072
    v_exp_f32 v30, v30
    v_exp_f32 v31, v31
    v_mfma_f32_16x16x32_bf16 v[112:115], v[176:179], v[48:51], v[112:115]
    v_exp_f32 v40, v40
    v_exp_f32 v41, v41
    v_mfma_f32_16x16x32_bf16 v[116:119], v[176:179], v[52:55], v[116:119]
    v_exp_f32 v42, v42
    v_exp_f32 v43, v43
    v_mfma_f32_16x16x32_bf16 v[16:19], v[144:147], v[96:99], v[0:3]
    v_exp_f32 v44, v44
    v_exp_f32 v45, v45
    v_mfma_f32_16x16x32_bf16 v[20:23], v[144:147], v[100:103], v[4:7]
    v_exp_f32 v46, v46
    v_exp_f32 v47, v47
    v_mfma_f32_16x16x32_bf16 v[32:35], v[148:151], v[96:99], v[0:3]
    v_perm_b32 v56, v25, v24, s51
    v_perm_b32 v57, v27, v26, s51
    v_perm_b32 v60, v29, v28, s51
    v_perm_b32 v61, v31, v30, s51
    v_mfma_f32_16x16x32_bf16 v[36:39], v[148:151], v[100:103], v[4:7]
    v_perm_b32 v58, v41, v40, s51
    v_perm_b32 v59, v43, v42, s51
    v_perm_b32 v62, v45, v44, s51
    v_perm_b32 v63, v47, v46, s51
    v_mfma_f32_16x16x32_bf16 v[72:75], v[136:139], v[56:59], v[72:75]
    v_exp_f32 v16, v16
    v_exp_f32 v17, v17
    v_mfma_f32_16x16x32_bf16 v[76:79], v[136:139], v[60:63], v[76:79]
    v_exp_f32 v18, v18
    v_exp_f32 v19, v19
    v_mfma_f32_16x16x32_bf16 v[88:91], v[140:143], v[56:59], v[88:91]
    v_exp_f32 v20, v20
    v_exp_f32 v21, v21
    v_mfma_f32_16x16x32_bf16 v[92:95], v[140:143], v[60:63], v[92:95]
    v_exp_f32 v22, v22
    v_exp_f32 v23, v23
    v_mfma_f32_16x16x32_bf16 v[120:123], v[176:179], v[56:59], v[120:123]
    v_exp_f32 v32, v32
    v_exp_f32 v33, v33
    v_mfma_f32_16x16x32_bf16 v[124:127], v[176:179], v[60:63], v[124:127]
    v_exp_f32 v34, v34
    v_exp_f32 v35, v35
    v_mfma_f32_16x16x32_bf16 v[24:27], v[144:147], v[104:107], v[8:11]
    v_exp_f32 v36, v36
    v_exp_f32 v37, v37
    v_mfma_f32_16x16x32_bf16 v[28:31], v[144:147], v[108:111], v[12:15]
    v_exp_f32 v38, v38
    v_exp_f32 v39, v39
    v_mfma_f32_16x16x32_bf16 v[40:43], v[148:151], v[104:107], v[8:11]
    v_perm_b32 v48, v17, v16, s51
    v_perm_b32 v49, v19, v18, s51
    v_perm_b32 v52, v21, v20, s51
    v_perm_b32 v53, v23, v22, s51
    v_mfma_f32_16x16x32_bf16 v[44:47], v[148:151], v[108:111], v[12:15]
    v_perm_b32 v50, v33, v32, s51
    v_perm_b32 v51, v35, v34, s51
    v_perm_b32 v54, v37, v36, s51
    v_perm_b32 v55, v39, v38, s51
    s_waitcnt lgkmcnt(0)
    v_mfma_f32_16x16x32_bf16 v[64:67], v[152:155], v[48:51], v[64:67]
    ds_read_b128 v[144:147], v203 offset:0
    v_exp_f32 v24, v24
    v_exp_f32 v25, v25
    v_mfma_f32_16x16x32_bf16 v[68:71], v[152:155], v[52:55], v[68:71]
    ds_read_b128 v[148:151], v203 offset:1024
    v_exp_f32 v26, v26
    v_exp_f32 v27, v27
    v_mfma_f32_16x16x32_bf16 v[80:83], v[156:159], v[48:51], v[80:83]
    ds_read_b128 v[136:139], v202 offset:2048
    v_exp_f32 v28, v28
    v_exp_f32 v29, v29
    v_mfma_f32_16x16x32_bf16 v[84:87], v[156:159], v[52:55], v[84:87]
    ds_read_b128 v[140:143], v202 offset:3072
    v_exp_f32 v30, v30
    v_exp_f32 v31, v31
    v_mfma_f32_16x16x32_bf16 v[112:115], v[176:179], v[48:51], v[112:115]
    v_exp_f32 v40, v40
    v_exp_f32 v41, v41
    v_mfma_f32_16x16x32_bf16 v[116:119], v[176:179], v[52:55], v[116:119]
    v_exp_f32 v42, v42
    v_exp_f32 v43, v43
    v_mfma_f32_16x16x32_bf16 v[16:19], v[128:131], v[96:99], v[0:3]
    v_exp_f32 v44, v44
    v_exp_f32 v45, v45
    v_mfma_f32_16x16x32_bf16 v[20:23], v[128:131], v[100:103], v[4:7]
    v_exp_f32 v46, v46
    v_exp_f32 v47, v47
    v_mfma_f32_16x16x32_bf16 v[32:35], v[132:135], v[96:99], v[0:3]
    v_perm_b32 v56, v25, v24, s51
    v_perm_b32 v57, v27, v26, s51
    v_perm_b32 v60, v29, v28, s51
    v_perm_b32 v61, v31, v30, s51
    v_mfma_f32_16x16x32_bf16 v[36:39], v[132:135], v[100:103], v[4:7]
    v_perm_b32 v58, v41, v40, s51
    v_perm_b32 v59, v43, v42, s51
    v_perm_b32 v62, v45, v44, s51
    v_perm_b32 v63, v47, v46, s51
    v_add_u32 v185, 4294959104, v185
    v_add_u32 v201, 4294959104, v201
    s_sub_u32 s48, s48, 1
    s_cmp_lg_u32 s48, s49
    s_cbranch_scc1 L_concat_att_cont
    s_cmp_eq_u32 s18, 0
    s_cbranch_scc0 L_concat_att_cont
    v_mfma_f32_16x16x32_bf16 v[72:75], v[152:155], v[56:59], v[72:75]
    v_mfma_f32_16x16x32_bf16 v[76:79], v[152:155], v[60:63], v[76:79]
    v_mfma_f32_16x16x32_bf16 v[88:91], v[156:159], v[56:59], v[88:91]
    v_mfma_f32_16x16x32_bf16 v[92:95], v[156:159], v[60:63], v[92:95]
    v_mfma_f32_16x16x32_bf16 v[120:123], v[176:179], v[56:59], v[120:123]
    v_mfma_f32_16x16x32_bf16 v[124:127], v[176:179], v[60:63], v[124:127]
    s_branch L_concat_att_fin
L_concat_att_cont:
    s_sub_u32 s48, s48, 1
    s_cmp_gt_u32 s48, 1
    s_cbranch_scc1 L_concat_att_loop
    v_mfma_f32_16x16x32_bf16 v[72:75], v[152:155], v[56:59], v[72:75]
    v_mfma_f32_16x16x32_bf16 v[76:79], v[152:155], v[60:63], v[76:79]
    v_mfma_f32_16x16x32_bf16 v[88:91], v[156:159], v[56:59], v[88:91]
    v_mfma_f32_16x16x32_bf16 v[92:95], v[156:159], v[60:63], v[92:95]
    v_mfma_f32_16x16x32_bf16 v[120:123], v[176:179], v[56:59], v[120:123]
    v_mfma_f32_16x16x32_bf16 v[124:127], v[176:179], v[60:63], v[124:127]
    ds_read_b128 v[152:155], v184 offset:2048
    ds_read_b128 v[156:159], v184 offset:3072
    s_waitcnt lgkmcnt(2)
    v_cndmask_b32 v160, v182, v196, s[40:41]
    v_cndmask_b32 v161, v182, v196, s[42:43]
    v_cndmask_b32 v162, v182, v196, s[44:45]
    v_cndmask_b32 v163, v182, v196, s[46:47]
    v_cndmask_b32 v164, v183, v196, s[40:41]
    v_cndmask_b32 v165, v183, v196, s[42:43]
    v_cndmask_b32 v166, v183, v196, s[44:45]
    v_cndmask_b32 v167, v183, v196, s[46:47]
    v_mfma_f32_16x16x32_bf16 v[16:19], v[128:131], v[96:99], v[0:3]
    v_mfma_f32_16x16x32_bf16 v[20:23], v[128:131], v[100:103], v[4:7]
    v_mfma_f32_16x16x32_bf16 v[24:27], v[128:131], v[104:107], v[160:163]
    v_mfma_f32_16x16x32_bf16 v[32:35], v[132:135], v[96:99], v[0:3]
    v_mfma_f32_16x16x32_bf16 v[36:39], v[132:135], v[100:103], v[4:7]
    v_mfma_f32_16x16x32_bf16 v[40:43], v[132:135], v[104:107], v[8:11]
    v_mfma_f32_16x16x32_bf16 v[44:47], v[132:135], v[108:111], v[164:167]
    s_nop 1
    v_exp_f32 v16, v16
    v_exp_f32 v17, v17
    v_exp_f32 v18, v18
    v_exp_f32 v19, v19
    v_exp_f32 v20, v20
    v_exp_f32 v21, v21
    v_exp_f32 v22, v22
    v_exp_f32 v23, v23
    v_exp_f32 v24, v24
    v_exp_f32 v25, v25
    v_exp_f32 v26, v26
    v_exp_f32 v27, v27
    v_mov_b32 v60, 0
    v_mov_b32 v61, 0
    v_exp_f32 v32, v32
    v_exp_f32 v33, v33
    v_exp_f32 v34, v34
    v_exp_f32 v35, v35
    v_exp_f32 v36, v36
    v_exp_f32 v37, v37
    v_exp_f32 v38, v38
    v_exp_f32 v39, v39
    v_exp_f32 v40, v40
    v_exp_f32 v41, v41
    v_exp_f32 v42, v42
    v_exp_f32 v43, v43
    v_exp_f32 v44, v44
    v_exp_f32 v45, v45
    v_exp_f32 v46, v46
    v_exp_f32 v47, v47
    v_perm_b32 v48, v17, v16, s51
    v_perm_b32 v49, v19, v18, s51
    v_perm_b32 v52, v21, v20, s51
    v_perm_b32 v53, v23, v22, s51
    v_perm_b32 v56, v25, v24, s51
    v_perm_b32 v57, v27, v26, s51
    v_perm_b32 v50, v33, v32, s51
    v_perm_b32 v51, v35, v34, s51
    v_perm_b32 v54, v37, v36, s51
    v_perm_b32 v55, v39, v38, s51
    v_perm_b32 v58, v41, v40, s51
    v_perm_b32 v59, v43, v42, s51
    v_perm_b32 v62, v45, v44, s51
    v_perm_b32 v63, v47, v46, s51
    v_mfma_f32_16x16x32_bf16 v[64:67], v[136:139], v[48:51], v[64:67]
    v_mfma_f32_16x16x32_bf16 v[68:71], v[136:139], v[52:55], v[68:71]
    v_mfma_f32_16x16x32_bf16 v[72:75], v[136:139], v[56:59], v[72:75]
    v_mfma_f32_16x16x32_bf16 v[76:79], v[136:139], v[60:63], v[76:79]
    v_mfma_f32_16x16x32_bf16 v[80:83], v[140:143], v[48:51], v[80:83]
    v_mfma_f32_16x16x32_bf16 v[84:87], v[140:143], v[52:55], v[84:87]
    v_mfma_f32_16x16x32_bf16 v[88:91], v[140:143], v[56:59], v[88:91]
    v_mfma_f32_16x16x32_bf16 v[92:95], v[140:143], v[60:63], v[92:95]
    v_mfma_f32_16x16x32_bf16 v[112:115], v[176:179], v[48:51], v[112:115]
    v_mfma_f32_16x16x32_bf16 v[116:119], v[176:179], v[52:55], v[116:119]
    v_mfma_f32_16x16x32_bf16 v[120:123], v[176:179], v[56:59], v[120:123]
    v_mfma_f32_16x16x32_bf16 v[124:127], v[176:179], v[60:63], v[124:127]
    s_waitcnt lgkmcnt(0)
    v_cndmask_b32 v160, v180, v196, s[40:41]
    v_cndmask_b32 v161, v180, v196, s[42:43]
    v_cndmask_b32 v162, v180, v196, s[44:45]
    v_cndmask_b32 v163, v180, v196, s[46:47]
    v_cndmask_b32 v164, v181, v196, s[40:41]
    v_cndmask_b32 v165, v181, v196, s[42:43]
    v_cndmask_b32 v166, v181, v196, s[44:45]
    v_cndmask_b32 v167, v181, v196, s[46:47]
    v_mfma_f32_16x16x32_bf16 v[16:19], v[144:147], v[96:99], v[160:163]
    v_mfma_f32_16x16x32_bf16 v[32:35], v[148:151], v[96:99], v[0:3]
    v_mfma_f32_16x16x32_bf16 v[36:39], v[148:151], v[100:103], v[164:167]
    s_nop 5
    v_exp_f32 v16, v16
    v_exp_f32 v17, v17
    v_exp_f32 v18, v18
    v_exp_f32 v19, v19
    v_mov_b32 v52, 0
    v_mov_b32 v53, 0
    v_exp_f32 v32, v32
    v_exp_f32 v33, v33
    v_exp_f32 v34, v34
    v_exp_f32 v35, v35
    v_exp_f32 v36, v36
    v_exp_f32 v37, v37
    v_exp_f32 v38, v38
    v_exp_f32 v39, v39
    v_perm_b32 v48, v17, v16, s51
    v_perm_b32 v49, v19, v18, s51
    v_perm_b32 v50, v33, v32, s51
    v_perm_b32 v51, v35, v34, s51
    v_perm_b32 v54, v37, v36, s51
    v_perm_b32 v55, v39, v38, s51
    v_mfma_f32_16x16x32_bf16 v[64:67], v[152:155], v[48:51], v[64:67]
    s_nop 0
    v_mfma_f32_16x16x32_bf16 v[68:71], v[152:155], v[52:55], v[68:71]
    v_mfma_f32_16x16x32_bf16 v[80:83], v[156:159], v[48:51], v[80:83]
    v_mfma_f32_16x16x32_bf16 v[84:87], v[156:159], v[52:55], v[84:87]
    v_mfma_f32_16x16x32_bf16 v[112:115], v[176:179], v[48:51], v[112:115]
    v_mfma_f32_16x16x32_bf16 v[116:119], v[176:179], v[52:55], v[116:119]
L_concat_att_fin:
    s_nop 7
    s_cmp_eq_u32 s50, 1
    s_cbranch_scc1 L_concat_att_done
    s_mov_b32 s29, 0x4e800000
    v_add_f32 v189, v112, v116
    v_add_f32 v190, v120, v124
    v_add_f32 v189, v189, v190
    v_cmp_gt_f32 vcc, s29, v189
    s_nop 0
    s_cmp_eq_u64 vcc, exec
    s_cbranch_scc1 L_concat_att_done
    v_mov_b32 v180, v196
    v_mov_b32 v181, v196
    v_mov_b32 v182, v196
    v_mov_b32 v183, v196
    v_mov_b32 v0, 0
    v_mov_b32 v1, 0
    v_mov_b32 v2, 0
    v_mov_b32 v3, 0
    v_mov_b32 v4, 0
    v_mov_b32 v5, 0
    v_mov_b32 v6, 0
    v_mov_b32 v7, 0
    v_mov_b32 v8, 0
    v_mov_b32 v9, 0
    v_mov_b32 v10, 0
    v_mov_b32 v11, 0
    v_mov_b32 v12, 0
    v_mov_b32 v13, 0
    v_mov_b32 v14, 0
    v_mov_b32 v15, 0
    s_cmp_eq_u32 s18, 0
    s_cbranch_scc1 L_concat_tm_r0
    ds_read_b128 v[128:131], v184 offset:0
    ds_read_b128 v[132:135], v184 offset:1024
    s_waitcnt lgkmcnt(0)
    v_cndmask_b32 v160, v198, v196, s[40:41]
    v_cndmask_b32 v161, v198, v196, s[42:43]
    v_cndmask_b32 v162, v198, v196, s[44:45]
    v_cndmask_b32 v163, v198, v196, s[46:47]
    s_nop 1
    v_mfma_f32_16x16x32_bf16 v[16:19], v[128:131], v[96:99], v[160:163]
    s_nop 7
    v_max3_f32 v180, v180, v16, v17
    v_max3_f32 v180, v180, v18, v19
    v_mfma_f32_16x16x32_bf16 v[16:19], v[132:135], v[96:99], v[0:3]
    s_nop 7
    v_max3_f32 v180, v180, v16, v17
    v_max3_f32 v180, v180, v18, v19
    v_cndmask_b32 v160, v198, v196, s[40:41]
    v_cndmask_b32 v161, v198, v196, s[42:43]
    v_cndmask_b32 v162, v198, v196, s[44:45]
    v_cndmask_b32 v163, v198, v196, s[46:47]
    s_nop 1
    v_mfma_f32_16x16x32_bf16 v[16:19], v[132:135], v[100:103], v[160:163]
    s_nop 7
    v_max3_f32 v181, v181, v16, v17
    v_max3_f32 v181, v181, v18, v19
    ds_read_b128 v[128:131], v184 offset:4096
    ds_read_b128 v[132:135], v184 offset:5120
    s_waitcnt lgkmcnt(0)
    v_mfma_f32_16x16x32_bf16 v[16:19], v[128:131], v[96:99], v[0:3]
    s_nop 7
    v_max3_f32 v180, v180, v16, v17
    v_max3_f32 v180, v180, v18, v19
    v_mfma_f32_16x16x32_bf16 v[16:19], v[132:135], v[96:99], v[0:3]
    s_nop 7
    v_max3_f32 v180, v180, v16, v17
    v_max3_f32 v180, v180, v18, v19
    v_mfma_f32_16x16x32_bf16 v[16:19], v[128:131], v[100:103], v[0:3]
    s_nop 7
    v_max3_f32 v181, v181, v16, v17
    v_max3_f32 v181, v181, v18, v19
    v_mfma_f32_16x16x32_bf16 v[16:19], v[132:135], v[100:103], v[0:3]
    s_nop 7
    v_max3_f32 v181, v181, v16, v17
    v_max3_f32 v181, v181, v18, v19
    v_cndmask_b32 v160, v198, v196, s[40:41]
    v_cndmask_b32 v161, v198, v196, s[42:43]
    v_cndmask_b32 v162, v198, v196, s[44:45]
    v_cndmask_b32 v163, v198, v196, s[46:47]
    s_nop 1
    v_mfma_f32_16x16x32_bf16 v[16:19], v[128:131], v[104:107], v[160:163]
    s_nop 7
    v_max3_f32 v182, v182, v16, v17
    v_max3_f32 v182, v182, v18, v19
    v_mfma_f32_16x16x32_bf16 v[16:19], v[132:135], v[104:107], v[0:3]
    s_nop 7
    v_max3_f32 v182, v182, v16, v17
    v_max3_f32 v182, v182, v18, v19
    v_cndmask_b32 v160, v198, v196, s[40:41]
    v_cndmask_b32 v161, v198, v196, s[42:43]
    v_cndmask_b32 v162, v198, v196, s[44:45]
    v_cndmask_b32 v163, v198, v196, s[46:47]
    s_nop 1
    v_mfma_f32_16x16x32_bf16 v[16:19], v[132:135], v[108:111], v[160:163]
    s_nop 7
    v_max3_f32 v183, v183, v16, v17
    v_max3_f32 v183, v183, v18, v19
    s_mov_b32 s48, 2
    s_branch L_concat_tm_mid
L_concat_tm_r0:
    s_mov_b32 s48, s49
L_concat_tm_mid:
    s_lshl_b32 s29, s48, 12
    v_add_u32 v197, s29, v184
    s_cmp_ge_u32 s48, 8
    s_cbranch_scc1 L_concat_tm_tail
L_concat_tm_loop:
    ds_read_b128 v[128:131], v197 offset:0
    ds_read_b128 v[132:135], v197 offset:1024
    s_waitcnt lgkmcnt(0)
    v_mfma_f32_16x16x32_bf16 v[16:19], v[128:131], v[96:99], v[0:3]
    s_nop 7
    v_max3_f32 v180, v180, v16, v17
    v_max3_f32 v180, v180, v18, v19
    v_mfma_f32_16x16x32_bf16 v[16:19], v[132:135], v[96:99], v[0:3]
    s_nop 7
    v_max3_f32 v180, v180, v16, v17
    v_max3_f32 v180, v180, v18, v19
    v_mfma_f32_16x16x32_bf16 v[16:19], v[128:131], v[100:103], v[0:3]
    s_nop 7
    v_max3_f32 v181, v181, v16, v17
    v_max3_f32 v181, v181, v18, v19
    v_mfma_f32_16x16x32_bf16 v[16:19], v[132:135], v[100:103], v[0:3]
    s_nop 7
    v_max3_f32 v181, v181, v16, v17
    v_max3_f32 v181, v181, v18, v19
    v_mfma_f32_16x16x32_bf16 v[16:19], v[128:131], v[104:107], v[0:3]
    s_nop 7
    v_max3_f32 v182, v182, v16, v17
    v_max3_f32 v182, v182, v18, v19
    v_mfma_f32_16x16x32_bf16 v[16:19], v[132:135], v[104:107], v[0:3]
    s_nop 7
    v_max3_f32 v182, v182, v16, v17
    v_max3_f32 v182, v182, v18, v19
    v_mfma_f32_16x16x32_bf16 v[16:19], v[128:131], v[108:111], v[0:3]
    s_nop 7
    v_max3_f32 v183, v183, v16, v17
    v_max3_f32 v183, v183, v18, v19
    v_mfma_f32_16x16x32_bf16 v[16:19], v[132:135], v[108:111], v[0:3]
    s_nop 7
    v_max3_f32 v183, v183, v16, v17
    v_max3_f32 v183, v183, v18, v19
    v_add_u32 v197, 4096, v197
    s_add_u32 s48, s48, 1
    s_cmp_lt_u32 s48, 8
    s_cbranch_scc1 L_concat_tm_loop
L_concat_tm_tail:
    ds_read_b128 v[128:131], v184 offset:32768
    ds_read_b128 v[132:135], v184 offset:33792
    s_waitcnt lgkmcnt(0)
    v_cndmask_b32 v160, v196, v198, s[40:41]
    v_cndmask_b32 v161, v196, v198, s[42:43]
    v_cndmask_b32 v162, v196, v198, s[44:45]
    v_cndmask_b32 v163, v196, v198, s[46:47]
    s_nop 1
    v_mfma_f32_16x16x32_bf16 v[16:19], v[128:131], v[96:99], v[160:163]
    s_nop 7
    v_max3_f32 v180, v180, v16, v17
    v_max3_f32 v180, v180, v18, v19
    v_mfma_f32_16x16x32_bf16 v[16:19], v[128:131], v[100:103], v[0:3]
    s_nop 7
    v_max3_f32 v181, v181, v16, v17
    v_max3_f32 v181, v181, v18, v19
    v_cndmask_b32 v160, v196, v198, s[40:41]
    v_cndmask_b32 v161, v196, v198, s[42:43]
    v_cndmask_b32 v162, v196, v198, s[44:45]
    v_cndmask_b32 v163, v196, v198, s[46:47]
    s_nop 1
    v_mfma_f32_16x16x32_bf16 v[16:19], v[132:135], v[100:103], v[160:163]
    s_nop 7
    v_max3_f32 v181, v181, v16, v17
    v_max3_f32 v181, v181, v18, v19
    v_mfma_f32_16x16x32_bf16 v[16:19], v[128:131], v[104:107], v[0:3]
    s_nop 7
    v_max3_f32 v182, v182, v16, v17
    v_max3_f32 v182, v182, v18, v19
    v_mfma_f32_16x16x32_bf16 v[16:19], v[132:135], v[104:107], v[0:3]
    s_nop 7
    v_max3_f32 v182, v182, v16, v17
    v_max3_f32 v182, v182, v18, v19
    v_mfma_f32_16x16x32_bf16 v[16:19], v[128:131], v[108:111], v[0:3]
    s_nop 7
    v_max3_f32 v183, v183, v16, v17
    v_max3_f32 v183, v183, v18, v19
    v_mfma_f32_16x16x32_bf16 v[16:19], v[132:135], v[108:111], v[0:3]
    s_nop 7
    v_max3_f32 v183, v183, v16, v17
    v_max3_f32 v183, v183, v18, v19
    ds_read_b128 v[128:131], v184 offset:36864
    ds_read_b128 v[132:135], v184 offset:37888
    s_waitcnt lgkmcnt(0)
    v_cndmask_b32 v160, v196, v198, s[40:41]
    v_cndmask_b32 v161, v196, v198, s[42:43]
    v_cndmask_b32 v162, v196, v198, s[44:45]
    v_cndmask_b32 v163, v196, v198, s[46:47]
    s_nop 1
    v_mfma_f32_16x16x32_bf16 v[16:19], v[128:131], v[104:107], v[160:163]
    s_nop 7
    v_max3_f32 v182, v182, v16, v17
    v_max3_f32 v182, v182, v18, v19
    v_mfma_f32_16x16x32_bf16 v[16:19], v[128:131], v[108:111], v[0:3]
    s_nop 7
    v_max3_f32 v183, v183, v16, v17
    v_max3_f32 v183, v183, v18, v19
    v_cndmask_b32 v160, v196, v198, s[40:41]
    v_cndmask_b32 v161, v196, v198, s[42:43]
    v_cndmask_b32 v162, v196, v198, s[44:45]
    v_cndmask_b32 v163, v196, v198, s[46:47]
    s_nop 1
    v_mfma_f32_16x16x32_bf16 v[16:19], v[132:135], v[108:111], v[160:163]
    s_nop 7
    v_max3_f32 v183, v183, v16, v17
    v_max3_f32 v183, v183, v18, v19
    v_mov_b32 v192, v180
    s_nop 1
    v_permlane32_swap_b32 v180, v192
    v_max_f32 v180, v180, v192
    v_mov_b32 v192, v180
    s_nop 1
    v_permlane16_swap_b32 v180, v192
    v_max_f32 v180, v180, v192
    v_mov_b32 v193, v181
    s_nop 1
    v_permlane32_swap_b32 v181, v193
    v_max_f32 v181, v181, v193
    v_mov_b32 v193, v181
    s_nop 1
    v_permlane16_swap_b32 v181, v193
    v_max_f32 v181, v181, v193
    v_mov_b32 v194, v182
    s_nop 1
    v_permlane32_swap_b32 v182, v194
    v_max_f32 v182, v182, v194
    v_mov_b32 v194, v182
    s_nop 1
    v_permlane16_swap_b32 v182, v194
    v_max_f32 v182, v182, v194
    v_mov_b32 v195, v183
    s_nop 1
    v_permlane32_swap_b32 v183, v195
    v_max_f32 v183, v183, v195
    v_mov_b32 v195, v183
    s_nop 1
    v_permlane16_swap_b32 v183, v195
    v_max_f32 v183, v183, v195
    v_sub_f32 v180, 0, v180
    v_sub_f32 v181, 0, v181
    v_sub_f32 v182, 0, v182
    v_sub_f32 v183, 0, v183
    s_mov_b32 s50, 1
    s_branch L_concat_att_pass
L_concat_att_done:
    v_rcp_f32 v188, v112
    v_rcp_f32 v189, v116
    v_rcp_f32 v190, v120
    v_rcp_f32 v191, v124
    v_mul_f32 v64, v188, v64
    v_mul_f32 v65, v188, v65
    v_mul_f32 v66, v188, v66
    v_mul_f32 v67, v188, v67
    v_mul_f32 v80, v188, v80
    v_mul_f32 v81, v188, v81
    v_mul_f32 v82, v188, v82
    v_mul_f32 v83, v188, v83
    v_mul_f32 v68, v189, v68
    v_mul_f32 v69, v189, v69
    v_mul_f32 v70, v189, v70
    v_mul_f32 v71, v189, v71
    v_mul_f32 v84, v189, v84
    v_mul_f32 v85, v189, v85
    v_mul_f32 v86, v189, v86
    v_mul_f32 v87, v189, v87
    v_mul_f32 v72, v190, v72
    v_mul_f32 v73, v190, v73
    v_mul_f32 v74, v190, v74
    v_mul_f32 v75, v190, v75
    v_mul_f32 v88, v190, v88
    v_mul_f32 v89, v190, v89
    v_mul_f32 v90, v190, v90
    v_mul_f32 v91, v190, v91
    v_mul_f32 v76, v191, v76
    v_mul_f32 v77, v191, v77
    v_mul_f32 v78, v191, v78
    v_mul_f32 v79, v191, v79
    v_mul_f32 v92, v191, v92
    v_mul_f32 v93, v191, v93
    v_mul_f32 v94, v191, v94
    v_mul_f32 v95, v191, v95
    v_cvt_pk_bf16_f32 v48, v64, v65
    v_cvt_pk_bf16_f32 v49, v66, v67
    v_cvt_pk_bf16_f32 v50, v80, v81
    v_cvt_pk_bf16_f32 v51, v82, v83
    v_cvt_pk_bf16_f32 v52, v68, v69
    v_cvt_pk_bf16_f32 v53, v70, v71
    v_cvt_pk_bf16_f32 v54, v84, v85
    v_cvt_pk_bf16_f32 v55, v86, v87
    v_cvt_pk_bf16_f32 v56, v72, v73
    v_cvt_pk_bf16_f32 v57, v74, v75
    v_cvt_pk_bf16_f32 v58, v88, v89
    v_cvt_pk_bf16_f32 v59, v90, v91
    v_cvt_pk_bf16_f32 v60, v76, v77
    v_cvt_pk_bf16_f32 v61, v78, v79
    v_cvt_pk_bf16_f32 v62, v92, v93
    v_cvt_pk_bf16_f32 v63, v94, v95
    s_waitcnt vmcnt(0)
    s_lshl_b32 s29, s17, 7
    s_lshl_b32 s30, s18, 4
    s_add_u32 s29, s29, s30
    s_lshl_b32 s30, s33, 2
    s_add_u32 s29, s29, s30
    s_lshl_b32 s29, s29, 5
    s_lshl_b32 s30, s32, 4
    s_add_u32 s29, s29, s30
    s_add_u32 s29, s29, s19
    s_lshl_b32 s29, s29, 10
    s_add_u32 s29, s29, 18874368
    v_lshlrev_b32 v188, 4, v255
    buffer_store_dwordx4 v[48:51], v188, s[12:15], s29 offen sc1
    s_add_u32 s29, s29, 32768
    buffer_store_dwordx4 v[52:55], v188, s[12:15], s29 offen sc1
    s_add_u32 s29, s29, 32768
    buffer_store_dwordx4 v[56:59], v188, s[12:15], s29 offen sc1
    s_add_u32 s29, s29, 32768
    buffer_store_dwordx4 v[60:63], v188, s[12:15], s29 offen sc1
    s_cmp_lg_u32 s32, 0
    s_cbranch_scc1 L_concat_o0_done
    s_waitcnt vmcnt(0)
    v_mov_b32 v199, 155660
    v_mov_b32 v200, 1
    s_mov_b64 s[58:59], exec
    s_mov_b64 exec, 1
    ds_add_rtn_u32 v200, v199, v200
    s_waitcnt lgkmcnt(0)
    v_readfirstlane_b32 s29, v200
    s_mov_b64 exec, s[58:59]
    s_cmp_lg_u32 s29, 3
    s_cbranch_scc1 L_concat_cs_o0
    s_mov_b64 s[58:59], exec
    s_mov_b64 exec, 1
    s_and_b32 s29, s100, 3
    s_lshl_b32 s29, s29, 3
    s_lshl_b32 s29, 1, s29
    s_andn2_b32 s30, s100, 3
    v_mov_b32 v199, s29
    v_mov_b32 v200, 0
    buffer_atomic_or v199, v200, s[12:15], s30 offen
    s_mov_b64 exec, s[58:59]
L_concat_cs_o0:
L_concat_o0_done:
L_concat_g3:
    s_mov_b32 s4, s86
    s_mov_b32 s5, s87
    s_mov_b32 s6, 8388608
    s_mov_b32 s7, 0x00020000
    v_lshrrev_b32 v148, 5, v255
    v_lshlrev_b32 v148, 10, v148
    v_bfe_u32 v149, v255, 4, 1
    v_lshl_add_u32 v148, v149, 9, v148
    v_bfe_u32 v150, v255, 2, 2
    v_lshl_add_u32 v148, v150, 7, v148
    v_and_b32 v151, 3, v255
    v_lshl_add_u32 v148, v151, 3, v148
    v_lshrrev_b32 v150, 1, v150
    v_lshl_or_b32 v150, v149, 1, v150
    v_xor_b32 v151, 0, v150
    v_lshl_add_u32 v200, v151, 5, v148
    v_add_u32 v200, 131072, v200
    v_xor_b32 v151, 1, v150
    v_lshl_add_u32 v201, v151, 5, v148
    v_add_u32 v201, 131072, v201
    v_xor_b32 v151, 2, v150
    v_lshl_add_u32 v202, v151, 5, v148
    v_add_u32 v202, 131072, v202
    v_xor_b32 v151, 3, v150
    v_lshl_add_u32 v203, v151, 5, v148
    v_add_u32 v203, 131072, v203
    s_lshl_b32 s29, s83, 7
    s_lshl_b32 s30, s57, 4
    s_add_u32 s29, s29, s30
    s_lshl_b32 s30, s16, 1
    s_add_u32 s29, s29, s30
    s_lshl_b32 s29, s29, 15
    s_add_u32 s20, s29, 18874368
    v_lshlrev_b32 v186, 4, v255
    v_add_u32 v187, 32768, v186
    s_cmp_lg_u32 s16, 3
    s_cbranch_scc1 L_concat_pb_o
    s_mov_b32 s99, 0
L_concat_chk_o0:
    v_cmp_le_u32 vcc, 1, v206
    s_nop 0
    s_cmp_eq_u64 vcc, exec
    s_cbranch_scc1 L_concat_chkd_o0
    s_lshl_b32 s29, s83, 7
    s_lshl_b32 s30, s57, 4
    s_add_u32 s29, s29, s30
    v_and_b32 v145, 15, v255
    buffer_load_ubyte v206, v145, s[52:55], s29 offen sc1
    s_add_u32 s99, s99, 1
    s_waitcnt vmcnt(0)
    s_cmp_lt_u32 s99, 4194304
    s_cbranch_scc1 L_concat_chk_o0
L_concat_chkd_o0:
    s_lshl_b32 s29, s83, 3
    s_add_u32 s29, s29, s57
    s_lshl_b32 s29, s29, 7
    s_add_u32 s29, s29, 18350080
    v_and_b32 v145, 15, v255
    s_mov_b32 s99, 0
L_concat_poll_o0:
    buffer_load_ubyte v144, v145, s[12:15], s29 offen sc1
    s_add_u32 s99, s99, 1
    s_waitcnt vmcnt(0)
    v_cmp_eq_u32 vcc, 1, v144
    s_nop 0
    s_cmp_eq_u64 vcc, exec
    s_cbranch_scc1 L_concat_polld_o0
    s_cmp_ge_u32 s99, 4194304
    s_cbranch_scc1 L_concat_polld_o0
    s_branch L_concat_poll_o0
L_concat_polld_o0:
L_concat_pb_o:
    s_waitcnt lgkmcnt(0)
    s_barrier
    s_mov_b32 s21, s20
    s_lshl_b32 s24, s88, 10
    s_add_u32 s20, s21, s24
    s_setprio 3
    buffer_load_dwordx4 v[80:83], v186, s[12:15], s20 offen offset:0 sc1
    buffer_load_dwordx4 v[84:87], v187, s[12:15], s20 offen offset:0 sc1
    buffer_load_dwordx4 v[88:91], v186, s[12:15], s20 offen offset:1024 sc1
    buffer_load_dwordx4 v[92:95], v187, s[12:15], s20 offen offset:1024 sc1
    buffer_load_dwordx4 v[96:99], v186, s[12:15], s20 offen offset:2048 sc1
    buffer_load_dwordx4 v[100:103], v187, s[12:15], s20 offen offset:2048 sc1
    buffer_load_dwordx4 v[104:107], v186, s[12:15], s20 offen offset:3072 sc1
    buffer_load_dwordx4 v[108:111], v187, s[12:15], s20 offen offset:3072 sc1
    s_add_u32 s24, s24, 4096
    s_and_b32 s24, s24, 0x3fff
    s_add_u32 s20, s21, s24
    buffer_load_dwordx4 v[112:115], v186, s[12:15], s20 offen offset:0 sc1
    buffer_load_dwordx4 v[116:119], v187, s[12:15], s20 offen offset:0 sc1
    buffer_load_dwordx4 v[120:123], v186, s[12:15], s20 offen offset:1024 sc1
    buffer_load_dwordx4 v[124:127], v187, s[12:15], s20 offen offset:1024 sc1
    s_cmp_eq_u32 s17, 0
    s_cbranch_scc1 L_concat_g3_nb
    s_lshr_b32 s29, s16, 2
    s_lshl_b32 s29, s29, 12
    s_lshr_b32 s30, s90, 4
    s_add_u32 s29, s29, s30
    v_lshlrev_b32 v188, 4, v255
    v_add_u32 v188, s29, v188
    ds_write_b128 v188, v[208:211] offset:0
    ds_write_b128 v188, v[212:215] offset:8192
    ds_write_b128 v188, v[216:219] offset:16384
    ds_write_b128 v188, v[220:223] offset:24576
    ds_write_b128 v188, v[224:227] offset:32768
    ds_write_b128 v188, v[228:231] offset:40960
    ds_write_b128 v188, v[232:235] offset:49152
    ds_write_b128 v188, v[236:239] offset:57344
    v_add_u32 v188, 65536, v188
    ds_write_b128 v188, v[240:243] offset:0
    ds_write_b128 v188, v[244:247] offset:8192
    ds_write_b128 v188, v[248:251] offset:16384
    ds_write_b128 v188, v[168:171] offset:24576
    ds_write_b128 v188, v[172:175] offset:32768
L_concat_g3_nb:
    s_waitcnt lgkmcnt(0)
    s_barrier
    s_cmp_eq_u32 s17, 0
    s_cbranch_scc1 L_concat_g3_ns
    s_cmp_eq_u32 s32, 0
    s_cbranch_scc1 L_concat_g3_ns
    s_waitcnt vmcnt(0)
    v_mov_b32 v148, 155664
    v_mov_b32 v149, 1
    s_mov_b64 s[58:59], exec
    s_mov_b64 exec, 1
    ds_add_rtn_u32 v149, v148, v149
    s_waitcnt lgkmcnt(0)
    v_readfirstlane_b32 s29, v149
    s_mov_b64 exec, s[58:59]
    s_cmp_lg_u32 s29, 3
    s_cbranch_scc1 L_concat_cs_o1
    s_mov_b64 s[58:59], exec
    s_mov_b64 exec, 1
    s_and_b32 s29, s100, 3
    s_lshl_b32 s29, s29, 3
    s_lshl_b32 s29, 1, s29
    s_andn2_b32 s30, s100, 3
    v_mov_b32 v148, s29
    v_mov_b32 v149, 0
    buffer_atomic_or v148, v149, s[12:15], s30 offen offset:16
    s_mov_b64 exec, s[58:59]
L_concat_cs_o1:
L_concat_g3_ns:
    ds_read_b64_tr_b16 v[32:33], v200 offset:0
    ds_read_b64_tr_b16 v[34:35], v200 offset:2048
    ds_read_b64_tr_b16 v[36:37], v201 offset:0
    ds_read_b64_tr_b16 v[38:39], v201 offset:2048
    ds_read_b64_tr_b16 v[40:41], v202 offset:0
    ds_read_b64_tr_b16 v[42:43], v202 offset:2048
    ds_read_b64_tr_b16 v[44:45], v203 offset:0
    ds_read_b64_tr_b16 v[46:47], v203 offset:2048
    ds_read_b64_tr_b16 v[48:49], v200 offset:4096
    ds_read_b64_tr_b16 v[50:51], v200 offset:6144
    ds_read_b64_tr_b16 v[52:53], v201 offset:4096
    ds_read_b64_tr_b16 v[54:55], v201 offset:6144
    ds_read_b64_tr_b16 v[56:57], v202 offset:4096
    ds_read_b64_tr_b16 v[58:59], v202 offset:6144
    ds_read_b64_tr_b16 v[60:61], v203 offset:4096
    ds_read_b64_tr_b16 v[62:63], v203 offset:6144
    s_waitcnt vmcnt(10) lgkmcnt(8)
    v_mfma_f32_16x16x32_bf16 v[0:3], v[32:35], v[80:83], 0
    ds_read_b64_tr_b16 v[64:65], v200 offset:8192
    ds_read_b64_tr_b16 v[66:67], v200 offset:10240
    v_mfma_f32_16x16x32_bf16 v[16:19], v[32:35], v[84:87], 0
    ds_read_b64_tr_b16 v[68:69], v201 offset:8192
    ds_read_b64_tr_b16 v[70:71], v201 offset:10240
    v_mfma_f32_16x16x32_bf16 v[4:7], v[36:39], v[80:83], 0
    ds_read_b64_tr_b16 v[72:73], v202 offset:8192
    ds_read_b64_tr_b16 v[74:75], v202 offset:10240
    v_mfma_f32_16x16x32_bf16 v[20:23], v[36:39], v[84:87], 0
    ds_read_b64_tr_b16 v[76:77], v203 offset:8192
    ds_read_b64_tr_b16 v[78:79], v203 offset:10240
    v_mfma_f32_16x16x32_bf16 v[8:11], v[40:43], v[80:83], 0
    v_mfma_f32_16x16x32_bf16 v[24:27], v[40:43], v[84:87], 0
    v_mfma_f32_16x16x32_bf16 v[12:15], v[44:47], v[80:83], 0
    v_mfma_f32_16x16x32_bf16 v[28:31], v[44:47], v[84:87], 0
    buffer_load_dwordx4 v[80:83], v186, s[12:15], s20 offen offset:2048 sc1
    buffer_load_dwordx4 v[84:87], v187, s[12:15], s20 offen offset:2048 sc1
    s_waitcnt vmcnt(10) lgkmcnt(8)
    v_mfma_f32_16x16x32_bf16 v[0:3], v[48:51], v[88:91], v[0:3]
    ds_read_b64_tr_b16 v[32:33], v200 offset:12288
    ds_read_b64_tr_b16 v[34:35], v200 offset:14336
    v_mfma_f32_16x16x32_bf16 v[16:19], v[48:51], v[92:95], v[16:19]
    ds_read_b64_tr_b16 v[36:37], v201 offset:12288
    ds_read_b64_tr_b16 v[38:39], v201 offset:14336
    v_mfma_f32_16x16x32_bf16 v[4:7], v[52:55], v[88:91], v[4:7]
    ds_read_b64_tr_b16 v[40:41], v202 offset:12288
    ds_read_b64_tr_b16 v[42:43], v202 offset:14336
    v_mfma_f32_16x16x32_bf16 v[20:23], v[52:55], v[92:95], v[20:23]
    ds_read_b64_tr_b16 v[44:45], v203 offset:12288
    ds_read_b64_tr_b16 v[46:47], v203 offset:14336
    v_mfma_f32_16x16x32_bf16 v[8:11], v[56:59], v[88:91], v[8:11]
    v_mfma_f32_16x16x32_bf16 v[24:27], v[56:59], v[92:95], v[24:27]
    v_mfma_f32_16x16x32_bf16 v[12:15], v[60:63], v[88:91], v[12:15]
    v_mfma_f32_16x16x32_bf16 v[28:31], v[60:63], v[92:95], v[28:31]
    buffer_load_dwordx4 v[88:91], v186, s[12:15], s20 offen offset:3072 sc1
    buffer_load_dwordx4 v[92:95], v187, s[12:15], s20 offen offset:3072 sc1
    s_waitcnt vmcnt(10) lgkmcnt(8)
    v_mfma_f32_16x16x32_bf16 v[0:3], v[64:67], v[96:99], v[0:3]
    ds_read_b64_tr_b16 v[48:49], v200 offset:16384
    ds_read_b64_tr_b16 v[50:51], v200 offset:18432
    v_mfma_f32_16x16x32_bf16 v[16:19], v[64:67], v[100:103], v[16:19]
    ds_read_b64_tr_b16 v[52:53], v201 offset:16384
    ds_read_b64_tr_b16 v[54:55], v201 offset:18432
    v_mfma_f32_16x16x32_bf16 v[4:7], v[68:71], v[96:99], v[4:7]
    ds_read_b64_tr_b16 v[56:57], v202 offset:16384
    ds_read_b64_tr_b16 v[58:59], v202 offset:18432
    v_mfma_f32_16x16x32_bf16 v[20:23], v[68:71], v[100:103], v[20:23]
    ds_read_b64_tr_b16 v[60:61], v203 offset:16384
    ds_read_b64_tr_b16 v[62:63], v203 offset:18432
    v_mfma_f32_16x16x32_bf16 v[8:11], v[72:75], v[96:99], v[8:11]
    v_mfma_f32_16x16x32_bf16 v[24:27], v[72:75], v[100:103], v[24:27]
    v_mfma_f32_16x16x32_bf16 v[12:15], v[76:79], v[96:99], v[12:15]
    v_mfma_f32_16x16x32_bf16 v[28:31], v[76:79], v[100:103], v[28:31]
    s_add_u32 s24, s24, 4096
    s_and_b32 s24, s24, 0x3fff
    s_add_u32 s20, s21, s24
    buffer_load_dwordx4 v[96:99], v186, s[12:15], s20 offen offset:0 sc1
    buffer_load_dwordx4 v[100:103], v187, s[12:15], s20 offen offset:0 sc1
    s_waitcnt vmcnt(10) lgkmcnt(8)
    v_mfma_f32_16x16x32_bf16 v[0:3], v[32:35], v[104:107], v[0:3]
    ds_read_b64_tr_b16 v[64:65], v200 offset:20480
    ds_read_b64_tr_b16 v[66:67], v200 offset:22528
    v_mfma_f32_16x16x32_bf16 v[16:19], v[32:35], v[108:111], v[16:19]
    ds_read_b64_tr_b16 v[68:69], v201 offset:20480
    ds_read_b64_tr_b16 v[70:71], v201 offset:22528
    v_mfma_f32_16x16x32_bf16 v[4:7], v[36:39], v[104:107], v[4:7]
    ds_read_b64_tr_b16 v[72:73], v202 offset:20480
    ds_read_b64_tr_b16 v[74:75], v202 offset:22528
    v_mfma_f32_16x16x32_bf16 v[20:23], v[36:39], v[108:111], v[20:23]
    ds_read_b64_tr_b16 v[76:77], v203 offset:20480
    ds_read_b64_tr_b16 v[78:79], v203 offset:22528
    v_mfma_f32_16x16x32_bf16 v[8:11], v[40:43], v[104:107], v[8:11]
    v_mfma_f32_16x16x32_bf16 v[24:27], v[40:43], v[108:111], v[24:27]
    v_mfma_f32_16x16x32_bf16 v[12:15], v[44:47], v[104:107], v[12:15]
    v_mfma_f32_16x16x32_bf16 v[28:31], v[44:47], v[108:111], v[28:31]
    buffer_load_dwordx4 v[104:107], v186, s[12:15], s20 offen offset:1024 sc1
    buffer_load_dwordx4 v[108:111], v187, s[12:15], s20 offen offset:1024 sc1
    s_waitcnt vmcnt(10) lgkmcnt(8)
    v_mfma_f32_16x16x32_bf16 v[0:3], v[48:51], v[112:115], v[0:3]
    v_add_u32 v200, 4294836224, v200
    v_add_u32 v201, 4294836224, v201
    v_mfma_f32_16x16x32_bf16 v[16:19], v[48:51], v[116:119], v[16:19]
    v_add_u32 v202, 4294836224, v202
    v_add_u32 v203, 4294836224, v203
    v_mfma_f32_16x16x32_bf16 v[4:7], v[52:55], v[112:115], v[4:7]
    ds_read_b64_tr_b16 v[32:33], v200 offset:0
    ds_read_b64_tr_b16 v[34:35], v200 offset:2048
    v_mfma_f32_16x16x32_bf16 v[20:23], v[52:55], v[116:119], v[20:23]
    ds_read_b64_tr_b16 v[36:37], v201 offset:0
    ds_read_b64_tr_b16 v[38:39], v201 offset:2048
    v_mfma_f32_16x16x32_bf16 v[8:11], v[56:59], v[112:115], v[8:11]
    ds_read_b64_tr_b16 v[40:41], v202 offset:0
    ds_read_b64_tr_b16 v[42:43], v202 offset:2048
    v_mfma_f32_16x16x32_bf16 v[24:27], v[56:59], v[116:119], v[24:27]
    ds_read_b64_tr_b16 v[44:45], v203 offset:0
    ds_read_b64_tr_b16 v[46:47], v203 offset:2048
    v_mfma_f32_16x16x32_bf16 v[12:15], v[60:63], v[112:115], v[12:15]
    v_mfma_f32_16x16x32_bf16 v[28:31], v[60:63], v[116:119], v[28:31]
    buffer_load_dwordx4 v[112:115], v186, s[12:15], s20 offen offset:2048 sc1
    buffer_load_dwordx4 v[116:119], v187, s[12:15], s20 offen offset:2048 sc1
    s_waitcnt vmcnt(10) lgkmcnt(8)
    v_mfma_f32_16x16x32_bf16 v[0:3], v[64:67], v[120:123], v[0:3]
    ds_read_b64_tr_b16 v[48:49], v200 offset:4096
    ds_read_b64_tr_b16 v[50:51], v200 offset:6144
    v_mfma_f32_16x16x32_bf16 v[16:19], v[64:67], v[124:127], v[16:19]
    ds_read_b64_tr_b16 v[52:53], v201 offset:4096
    ds_read_b64_tr_b16 v[54:55], v201 offset:6144
    v_mfma_f32_16x16x32_bf16 v[4:7], v[68:71], v[120:123], v[4:7]
    ds_read_b64_tr_b16 v[56:57], v202 offset:4096
    ds_read_b64_tr_b16 v[58:59], v202 offset:6144
    v_mfma_f32_16x16x32_bf16 v[20:23], v[68:71], v[124:127], v[20:23]
    ds_read_b64_tr_b16 v[60:61], v203 offset:4096
    ds_read_b64_tr_b16 v[62:63], v203 offset:6144
    v_mfma_f32_16x16x32_bf16 v[8:11], v[72:75], v[120:123], v[8:11]
    v_mfma_f32_16x16x32_bf16 v[24:27], v[72:75], v[124:127], v[24:27]
    v_mfma_f32_16x16x32_bf16 v[12:15], v[76:79], v[120:123], v[12:15]
    v_mfma_f32_16x16x32_bf16 v[28:31], v[76:79], v[124:127], v[28:31]
    buffer_load_dwordx4 v[120:123], v186, s[12:15], s20 offen offset:3072 sc1
    buffer_load_dwordx4 v[124:127], v187, s[12:15], s20 offen offset:3072 sc1
    s_waitcnt vmcnt(10) lgkmcnt(8)
    v_mfma_f32_16x16x32_bf16 v[0:3], v[32:35], v[80:83], v[0:3]
    ds_read_b64_tr_b16 v[64:65], v200 offset:8192
    ds_read_b64_tr_b16 v[66:67], v200 offset:10240
    v_mfma_f32_16x16x32_bf16 v[16:19], v[32:35], v[84:87], v[16:19]
    ds_read_b64_tr_b16 v[68:69], v201 offset:8192
    ds_read_b64_tr_b16 v[70:71], v201 offset:10240
    v_mfma_f32_16x16x32_bf16 v[4:7], v[36:39], v[80:83], v[4:7]
    ds_read_b64_tr_b16 v[72:73], v202 offset:8192
    ds_read_b64_tr_b16 v[74:75], v202 offset:10240
    v_mfma_f32_16x16x32_bf16 v[20:23], v[36:39], v[84:87], v[20:23]
    ds_read_b64_tr_b16 v[76:77], v203 offset:8192
    ds_read_b64_tr_b16 v[78:79], v203 offset:10240
    v_mfma_f32_16x16x32_bf16 v[8:11], v[40:43], v[80:83], v[8:11]
    v_mfma_f32_16x16x32_bf16 v[24:27], v[40:43], v[84:87], v[24:27]
    v_mfma_f32_16x16x32_bf16 v[12:15], v[44:47], v[80:83], v[12:15]
    v_mfma_f32_16x16x32_bf16 v[28:31], v[44:47], v[84:87], v[28:31]
    s_cmp_lg_u32 s16, 1
    s_cbranch_scc1 L_concat_op_done
    s_mov_b32 s99, 0
    s_branch L_concat_chkd_o1
L_concat_chk_o1:
    v_cmp_le_u32 vcc, 1, v206
    s_nop 0
    s_cmp_eq_u64 vcc, exec
    s_cbranch_scc1 L_concat_chkd_o1
    s_lshl_b32 s29, s83, 7
    s_lshl_b32 s30, s57, 4
    s_add_u32 s29, s29, s30
    v_and_b32 v145, 15, v255
    buffer_load_ubyte v206, v145, s[52:55], s29 offen sc1
    s_add_u32 s99, s99, 1
    s_waitcnt vmcnt(0)
    s_cmp_lt_u32 s99, 4194304
    s_cbranch_scc1 L_concat_chk_o1
L_concat_chkd_o1:
    s_lshl_b32 s29, s83, 3
    s_add_u32 s29, s29, s57
    s_lshl_b32 s29, s29, 7
    s_add_u32 s29, s29, 18350096
    v_and_b32 v145, 15, v255
    s_mov_b32 s99, 0
L_concat_poll_o1:
    buffer_load_ubyte v144, v145, s[12:15], s29 offen sc1
    s_add_u32 s99, s99, 1
    s_waitcnt vmcnt(0)
    v_cmp_eq_u32 vcc, 1, v144
    s_nop 0
    s_cmp_eq_u64 vcc, exec
    s_cbranch_scc1 L_concat_polld_o1
    s_cmp_ge_u32 s99, 4194304
    s_cbranch_scc1 L_concat_polld_o1
    s_branch L_concat_poll_o1
L_concat_polld_o1:
    v_mov_b32 v144, 155668
    v_mov_b32 v145, 1
    ds_write_b32 v144, v145
L_concat_op_done:
    s_add_u32 s24, s24, 4096
    s_and_b32 s24, s24, 0x3fff
    s_add_u32 s20, s21, s24
    buffer_load_dwordx4 v[80:83], v186, s[12:15], s20 offen offset:0 sc1
    buffer_load_dwordx4 v[84:87], v187, s[12:15], s20 offen offset:0 sc1
    s_waitcnt vmcnt(10) lgkmcnt(8)
    v_mfma_f32_16x16x32_bf16 v[0:3], v[48:51], v[88:91], v[0:3]
    ds_read_b64_tr_b16 v[32:33], v200 offset:12288
    ds_read_b64_tr_b16 v[34:35], v200 offset:14336
    v_mfma_f32_16x16x32_bf16 v[16:19], v[48:51], v[92:95], v[16:19]
    ds_read_b64_tr_b16 v[36:37], v201 offset:12288
    ds_read_b64_tr_b16 v[38:39], v201 offset:14336
    v_mfma_f32_16x16x32_bf16 v[4:7], v[52:55], v[88:91], v[4:7]
    ds_read_b64_tr_b16 v[40:41], v202 offset:12288
    ds_read_b64_tr_b16 v[42:43], v202 offset:14336
    v_mfma_f32_16x16x32_bf16 v[20:23], v[52:55], v[92:95], v[20:23]
    ds_read_b64_tr_b16 v[44:45], v203 offset:12288
    ds_read_b64_tr_b16 v[46:47], v203 offset:14336
    v_mfma_f32_16x16x32_bf16 v[8:11], v[56:59], v[88:91], v[8:11]
    v_mfma_f32_16x16x32_bf16 v[24:27], v[56:59], v[92:95], v[24:27]
    v_mfma_f32_16x16x32_bf16 v[12:15], v[60:63], v[88:91], v[12:15]
    v_mfma_f32_16x16x32_bf16 v[28:31], v[60:63], v[92:95], v[28:31]
    buffer_load_dwordx4 v[88:91], v186, s[12:15], s20 offen offset:1024 sc1
    buffer_load_dwordx4 v[92:95], v187, s[12:15], s20 offen offset:1024 sc1
    s_setprio 2
    s_waitcnt vmcnt(10) lgkmcnt(8)
    v_mfma_f32_16x16x32_bf16 v[0:3], v[64:67], v[96:99], v[0:3]
    ds_read_b64_tr_b16 v[48:49], v200 offset:16384
    ds_read_b64_tr_b16 v[50:51], v200 offset:18432
    v_mfma_f32_16x16x32_bf16 v[16:19], v[64:67], v[100:103], v[16:19]
    ds_read_b64_tr_b16 v[52:53], v201 offset:16384
    ds_read_b64_tr_b16 v[54:55], v201 offset:18432
    v_mfma_f32_16x16x32_bf16 v[4:7], v[68:71], v[96:99], v[4:7]
    ds_read_b64_tr_b16 v[56:57], v202 offset:16384
    ds_read_b64_tr_b16 v[58:59], v202 offset:18432
    v_mfma_f32_16x16x32_bf16 v[20:23], v[68:71], v[100:103], v[20:23]
    ds_read_b64_tr_b16 v[60:61], v203 offset:16384
    ds_read_b64_tr_b16 v[62:63], v203 offset:18432
    v_mfma_f32_16x16x32_bf16 v[8:11], v[72:75], v[96:99], v[8:11]
    v_mfma_f32_16x16x32_bf16 v[24:27], v[72:75], v[100:103], v[24:27]
    v_mfma_f32_16x16x32_bf16 v[12:15], v[76:79], v[96:99], v[12:15]
    v_mfma_f32_16x16x32_bf16 v[28:31], v[76:79], v[100:103], v[28:31]
    buffer_load_dwordx4 v[96:99], v186, s[12:15], s20 offen offset:2048 sc1
    buffer_load_dwordx4 v[100:103], v187, s[12:15], s20 offen offset:2048 sc1
    s_waitcnt vmcnt(10) lgkmcnt(8)
    v_mfma_f32_16x16x32_bf16 v[0:3], v[32:35], v[104:107], v[0:3]
    ds_read_b64_tr_b16 v[64:65], v200 offset:20480
    ds_read_b64_tr_b16 v[66:67], v200 offset:22528
    v_mfma_f32_16x16x32_bf16 v[16:19], v[32:35], v[108:111], v[16:19]
    ds_read_b64_tr_b16 v[68:69], v201 offset:20480
    ds_read_b64_tr_b16 v[70:71], v201 offset:22528
    v_mfma_f32_16x16x32_bf16 v[4:7], v[36:39], v[104:107], v[4:7]
    ds_read_b64_tr_b16 v[72:73], v202 offset:20480
    ds_read_b64_tr_b16 v[74:75], v202 offset:22528
    v_mfma_f32_16x16x32_bf16 v[20:23], v[36:39], v[108:111], v[20:23]
    ds_read_b64_tr_b16 v[76:77], v203 offset:20480
    ds_read_b64_tr_b16 v[78:79], v203 offset:22528
    v_mfma_f32_16x16x32_bf16 v[8:11], v[40:43], v[104:107], v[8:11]
    v_mfma_f32_16x16x32_bf16 v[24:27], v[40:43], v[108:111], v[24:27]
    v_mfma_f32_16x16x32_bf16 v[12:15], v[44:47], v[104:107], v[12:15]
    v_mfma_f32_16x16x32_bf16 v[28:31], v[44:47], v[108:111], v[28:31]
    buffer_load_dwordx4 v[104:107], v186, s[12:15], s20 offen offset:3072 sc1
    buffer_load_dwordx4 v[108:111], v187, s[12:15], s20 offen offset:3072 sc1
    s_waitcnt vmcnt(10) lgkmcnt(8)
    v_mfma_f32_16x16x32_bf16 v[0:3], v[48:51], v[112:115], v[0:3]
    ds_read_b64_tr_b16 v[32:33], v200 offset:24576
    ds_read_b64_tr_b16 v[34:35], v200 offset:26624
    v_mfma_f32_16x16x32_bf16 v[16:19], v[48:51], v[116:119], v[16:19]
    ds_read_b64_tr_b16 v[36:37], v201 offset:24576
    ds_read_b64_tr_b16 v[38:39], v201 offset:26624
    v_mfma_f32_16x16x32_bf16 v[4:7], v[52:55], v[112:115], v[4:7]
    ds_read_b64_tr_b16 v[40:41], v202 offset:24576
    ds_read_b64_tr_b16 v[42:43], v202 offset:26624
    v_mfma_f32_16x16x32_bf16 v[20:23], v[52:55], v[116:119], v[20:23]
    ds_read_b64_tr_b16 v[44:45], v203 offset:24576
    ds_read_b64_tr_b16 v[46:47], v203 offset:26624
    v_mfma_f32_16x16x32_bf16 v[8:11], v[56:59], v[112:115], v[8:11]
    v_mfma_f32_16x16x32_bf16 v[24:27], v[56:59], v[116:119], v[24:27]
    v_mfma_f32_16x16x32_bf16 v[12:15], v[60:63], v[112:115], v[12:15]
    v_mfma_f32_16x16x32_bf16 v[28:31], v[60:63], v[116:119], v[28:31]
    v_mov_b32 v146, 155668
    s_mov_b32 s99, 0
L_concat_or:
    ds_read_b32 v147, v146
    s_add_u32 s99, s99, 1
    s_waitcnt lgkmcnt(0)
    v_readfirstlane_b32 s29, v147
    s_nop 0
    s_cmp_eq_u32 s29, 1
    s_cbranch_scc1 L_concat_or_d
    s_cmp_ge_u32 s99, 4194304
    s_cbranch_scc1 L_concat_or_d
    s_sleep 1
    s_branch L_concat_or
L_concat_or_d:
    s_lshl_b32 s24, s88, 10
    s_add_u32 s21, s21, 16384
    s_add_u32 s20, s21, s24
    buffer_load_dwordx4 v[112:115], v186, s[12:15], s20 offen offset:0 sc1
    buffer_load_dwordx4 v[116:119], v187, s[12:15], s20 offen offset:0 sc1
    s_waitcnt vmcnt(10) lgkmcnt(8)
    v_mfma_f32_16x16x32_bf16 v[0:3], v[64:67], v[120:123], v[0:3]
    ds_read_b64_tr_b16 v[48:49], v200 offset:28672
    ds_read_b64_tr_b16 v[50:51], v200 offset:30720
    v_mfma_f32_16x16x32_bf16 v[16:19], v[64:67], v[124:127], v[16:19]
    ds_read_b64_tr_b16 v[52:53], v201 offset:28672
    ds_read_b64_tr_b16 v[54:55], v201 offset:30720
    v_mfma_f32_16x16x32_bf16 v[4:7], v[68:71], v[120:123], v[4:7]
    ds_read_b64_tr_b16 v[56:57], v202 offset:28672
    ds_read_b64_tr_b16 v[58:59], v202 offset:30720
    v_mfma_f32_16x16x32_bf16 v[20:23], v[68:71], v[124:127], v[20:23]
    ds_read_b64_tr_b16 v[60:61], v203 offset:28672
    ds_read_b64_tr_b16 v[62:63], v203 offset:30720
    v_mfma_f32_16x16x32_bf16 v[8:11], v[72:75], v[120:123], v[8:11]
    v_mfma_f32_16x16x32_bf16 v[24:27], v[72:75], v[124:127], v[24:27]
    v_mfma_f32_16x16x32_bf16 v[12:15], v[76:79], v[120:123], v[12:15]
    v_mfma_f32_16x16x32_bf16 v[28:31], v[76:79], v[124:127], v[28:31]
    buffer_load_dwordx4 v[120:123], v186, s[12:15], s20 offen offset:1024 sc1
    buffer_load_dwordx4 v[124:127], v187, s[12:15], s20 offen offset:1024 sc1
    s_waitcnt vmcnt(10) lgkmcnt(8)
    v_mfma_f32_16x16x32_bf16 v[0:3], v[32:35], v[80:83], v[0:3]
    ds_read_b64_tr_b16 v[64:65], v200 offset:32768
    ds_read_b64_tr_b16 v[66:67], v200 offset:34816
    v_mfma_f32_16x16x32_bf16 v[16:19], v[32:35], v[84:87], v[16:19]
    ds_read_b64_tr_b16 v[68:69], v201 offset:32768
    ds_read_b64_tr_b16 v[70:71], v201 offset:34816
    v_mfma_f32_16x16x32_bf16 v[4:7], v[36:39], v[80:83], v[4:7]
    ds_read_b64_tr_b16 v[72:73], v202 offset:32768
    ds_read_b64_tr_b16 v[74:75], v202 offset:34816
    v_mfma_f32_16x16x32_bf16 v[20:23], v[36:39], v[84:87], v[20:23]
    ds_read_b64_tr_b16 v[76:77], v203 offset:32768
    ds_read_b64_tr_b16 v[78:79], v203 offset:34816
    v_mfma_f32_16x16x32_bf16 v[8:11], v[40:43], v[80:83], v[8:11]
    v_mfma_f32_16x16x32_bf16 v[24:27], v[40:43], v[84:87], v[24:27]
    v_mfma_f32_16x16x32_bf16 v[12:15], v[44:47], v[80:83], v[12:15]
    v_mfma_f32_16x16x32_bf16 v[28:31], v[44:47], v[84:87], v[28:31]
    buffer_load_dwordx4 v[80:83], v186, s[12:15], s20 offen offset:2048 sc1
    buffer_load_dwordx4 v[84:87], v187, s[12:15], s20 offen offset:2048 sc1
    s_waitcnt vmcnt(10) lgkmcnt(8)
    v_mfma_f32_16x16x32_bf16 v[0:3], v[48:51], v[88:91], v[0:3]
    ds_read_b64_tr_b16 v[32:33], v200 offset:36864
    ds_read_b64_tr_b16 v[34:35], v200 offset:38912
    v_mfma_f32_16x16x32_bf16 v[16:19], v[48:51], v[92:95], v[16:19]
    ds_read_b64_tr_b16 v[36:37], v201 offset:36864
    ds_read_b64_tr_b16 v[38:39], v201 offset:38912
    v_mfma_f32_16x16x32_bf16 v[4:7], v[52:55], v[88:91], v[4:7]
    ds_read_b64_tr_b16 v[40:41], v202 offset:36864
    ds_read_b64_tr_b16 v[42:43], v202 offset:38912
    v_mfma_f32_16x16x32_bf16 v[20:23], v[52:55], v[92:95], v[20:23]
    ds_read_b64_tr_b16 v[44:45], v203 offset:36864
    ds_read_b64_tr_b16 v[46:47], v203 offset:38912
    v_mfma_f32_16x16x32_bf16 v[8:11], v[56:59], v[88:91], v[8:11]
    v_mfma_f32_16x16x32_bf16 v[24:27], v[56:59], v[92:95], v[24:27]
    v_mfma_f32_16x16x32_bf16 v[12:15], v[60:63], v[88:91], v[12:15]
    v_mfma_f32_16x16x32_bf16 v[28:31], v[60:63], v[92:95], v[28:31]
    buffer_load_dwordx4 v[88:91], v186, s[12:15], s20 offen offset:3072 sc1
    buffer_load_dwordx4 v[92:95], v187, s[12:15], s20 offen offset:3072 sc1
    s_waitcnt vmcnt(10) lgkmcnt(8)
    v_mfma_f32_16x16x32_bf16 v[0:3], v[64:67], v[96:99], v[0:3]
    ds_read_b64_tr_b16 v[48:49], v200 offset:40960
    ds_read_b64_tr_b16 v[50:51], v200 offset:43008
    v_mfma_f32_16x16x32_bf16 v[16:19], v[64:67], v[100:103], v[16:19]
    ds_read_b64_tr_b16 v[52:53], v201 offset:40960
    ds_read_b64_tr_b16 v[54:55], v201 offset:43008
    v_mfma_f32_16x16x32_bf16 v[4:7], v[68:71], v[96:99], v[4:7]
    ds_read_b64_tr_b16 v[56:57], v202 offset:40960
    ds_read_b64_tr_b16 v[58:59], v202 offset:43008
    v_mfma_f32_16x16x32_bf16 v[20:23], v[68:71], v[100:103], v[20:23]
    ds_read_b64_tr_b16 v[60:61], v203 offset:40960
    ds_read_b64_tr_b16 v[62:63], v203 offset:43008
    v_mfma_f32_16x16x32_bf16 v[8:11], v[72:75], v[96:99], v[8:11]
    v_mfma_f32_16x16x32_bf16 v[24:27], v[72:75], v[100:103], v[24:27]
    v_mfma_f32_16x16x32_bf16 v[12:15], v[76:79], v[96:99], v[12:15]
    v_mfma_f32_16x16x32_bf16 v[28:31], v[76:79], v[100:103], v[28:31]
    s_add_u32 s24, s24, 4096
    s_and_b32 s24, s24, 0x3fff
    s_add_u32 s20, s21, s24
    buffer_load_dwordx4 v[96:99], v186, s[12:15], s20 offen offset:0 sc1
    buffer_load_dwordx4 v[100:103], v187, s[12:15], s20 offen offset:0 sc1
    s_waitcnt vmcnt(10) lgkmcnt(8)
    v_mfma_f32_16x16x32_bf16 v[0:3], v[32:35], v[104:107], v[0:3]
    ds_read_b64_tr_b16 v[64:65], v200 offset:45056
    ds_read_b64_tr_b16 v[66:67], v200 offset:47104
    v_mfma_f32_16x16x32_bf16 v[16:19], v[32:35], v[108:111], v[16:19]
    ds_read_b64_tr_b16 v[68:69], v201 offset:45056
    ds_read_b64_tr_b16 v[70:71], v201 offset:47104
    v_mfma_f32_16x16x32_bf16 v[4:7], v[36:39], v[104:107], v[4:7]
    ds_read_b64_tr_b16 v[72:73], v202 offset:45056
    ds_read_b64_tr_b16 v[74:75], v202 offset:47104
    v_mfma_f32_16x16x32_bf16 v[20:23], v[36:39], v[108:111], v[20:23]
    ds_read_b64_tr_b16 v[76:77], v203 offset:45056
    ds_read_b64_tr_b16 v[78:79], v203 offset:47104
    v_mfma_f32_16x16x32_bf16 v[8:11], v[40:43], v[104:107], v[8:11]
    v_mfma_f32_16x16x32_bf16 v[24:27], v[40:43], v[108:111], v[24:27]
    v_mfma_f32_16x16x32_bf16 v[12:15], v[44:47], v[104:107], v[12:15]
    v_mfma_f32_16x16x32_bf16 v[28:31], v[44:47], v[108:111], v[28:31]
    buffer_load_dwordx4 v[104:107], v186, s[12:15], s20 offen offset:1024 sc1
    buffer_load_dwordx4 v[108:111], v187, s[12:15], s20 offen offset:1024 sc1
    s_setprio 1
    s_waitcnt vmcnt(10) lgkmcnt(8)
    v_mfma_f32_16x16x32_bf16 v[0:3], v[48:51], v[112:115], v[0:3]
    ds_read_b64_tr_b16 v[32:33], v200 offset:49152
    ds_read_b64_tr_b16 v[34:35], v200 offset:51200
    v_mfma_f32_16x16x32_bf16 v[16:19], v[48:51], v[116:119], v[16:19]
    ds_read_b64_tr_b16 v[36:37], v201 offset:49152
    ds_read_b64_tr_b16 v[38:39], v201 offset:51200
    v_mfma_f32_16x16x32_bf16 v[4:7], v[52:55], v[112:115], v[4:7]
    ds_read_b64_tr_b16 v[40:41], v202 offset:49152
    ds_read_b64_tr_b16 v[42:43], v202 offset:51200
    v_mfma_f32_16x16x32_bf16 v[20:23], v[52:55], v[116:119], v[20:23]
    ds_read_b64_tr_b16 v[44:45], v203 offset:49152
    ds_read_b64_tr_b16 v[46:47], v203 offset:51200
    v_mfma_f32_16x16x32_bf16 v[8:11], v[56:59], v[112:115], v[8:11]
    v_mfma_f32_16x16x32_bf16 v[24:27], v[56:59], v[116:119], v[24:27]
    v_mfma_f32_16x16x32_bf16 v[12:15], v[60:63], v[112:115], v[12:15]
    v_mfma_f32_16x16x32_bf16 v[28:31], v[60:63], v[116:119], v[28:31]
    buffer_load_dwordx4 v[112:115], v186, s[12:15], s20 offen offset:2048 sc1
    buffer_load_dwordx4 v[116:119], v187, s[12:15], s20 offen offset:2048 sc1
    s_waitcnt vmcnt(10) lgkmcnt(8)
    v_mfma_f32_16x16x32_bf16 v[0:3], v[64:67], v[120:123], v[0:3]
    ds_read_b64_tr_b16 v[48:49], v200 offset:53248
    ds_read_b64_tr_b16 v[50:51], v200 offset:55296
    v_mfma_f32_16x16x32_bf16 v[16:19], v[64:67], v[124:127], v[16:19]
    ds_read_b64_tr_b16 v[52:53], v201 offset:53248
    ds_read_b64_tr_b16 v[54:55], v201 offset:55296
    v_mfma_f32_16x16x32_bf16 v[4:7], v[68:71], v[120:123], v[4:7]
    ds_read_b64_tr_b16 v[56:57], v202 offset:53248
    ds_read_b64_tr_b16 v[58:59], v202 offset:55296
    v_mfma_f32_16x16x32_bf16 v[20:23], v[68:71], v[124:127], v[20:23]
    ds_read_b64_tr_b16 v[60:61], v203 offset:53248
    ds_read_b64_tr_b16 v[62:63], v203 offset:55296
    v_mfma_f32_16x16x32_bf16 v[8:11], v[72:75], v[120:123], v[8:11]
    v_mfma_f32_16x16x32_bf16 v[24:27], v[72:75], v[124:127], v[24:27]
    v_mfma_f32_16x16x32_bf16 v[12:15], v[76:79], v[120:123], v[12:15]
    v_mfma_f32_16x16x32_bf16 v[28:31], v[76:79], v[124:127], v[28:31]
    buffer_load_dwordx4 v[120:123], v186, s[12:15], s20 offen offset:3072 sc1
    buffer_load_dwordx4 v[124:127], v187, s[12:15], s20 offen offset:3072 sc1
    s_waitcnt vmcnt(10) lgkmcnt(8)
    v_mfma_f32_16x16x32_bf16 v[0:3], v[32:35], v[80:83], v[0:3]
    ds_read_b64_tr_b16 v[64:65], v200 offset:57344
    ds_read_b64_tr_b16 v[66:67], v200 offset:59392
    v_mfma_f32_16x16x32_bf16 v[16:19], v[32:35], v[84:87], v[16:19]
    ds_read_b64_tr_b16 v[68:69], v201 offset:57344
    ds_read_b64_tr_b16 v[70:71], v201 offset:59392
    v_mfma_f32_16x16x32_bf16 v[4:7], v[36:39], v[80:83], v[4:7]
    ds_read_b64_tr_b16 v[72:73], v202 offset:57344
    ds_read_b64_tr_b16 v[74:75], v202 offset:59392
    v_mfma_f32_16x16x32_bf16 v[20:23], v[36:39], v[84:87], v[20:23]
    ds_read_b64_tr_b16 v[76:77], v203 offset:57344
    ds_read_b64_tr_b16 v[78:79], v203 offset:59392
    v_mfma_f32_16x16x32_bf16 v[8:11], v[40:43], v[80:83], v[8:11]
    v_mfma_f32_16x16x32_bf16 v[24:27], v[40:43], v[84:87], v[24:27]
    v_mfma_f32_16x16x32_bf16 v[12:15], v[44:47], v[80:83], v[12:15]
    v_mfma_f32_16x16x32_bf16 v[28:31], v[44:47], v[84:87], v[28:31]
    s_add_u32 s24, s24, 4096
    s_and_b32 s24, s24, 0x3fff
    s_add_u32 s20, s21, s24
    buffer_load_dwordx4 v[80:83], v186, s[12:15], s20 offen offset:0 sc1
    buffer_load_dwordx4 v[84:87], v187, s[12:15], s20 offen offset:0 sc1
    s_waitcnt vmcnt(10) lgkmcnt(8)
    v_mfma_f32_16x16x32_bf16 v[0:3], v[48:51], v[88:91], v[0:3]
    ds_read_b64_tr_b16 v[32:33], v200 offset:61440
    ds_read_b64_tr_b16 v[34:35], v200 offset:63488
    v_mfma_f32_16x16x32_bf16 v[16:19], v[48:51], v[92:95], v[16:19]
    ds_read_b64_tr_b16 v[36:37], v201 offset:61440
    ds_read_b64_tr_b16 v[38:39], v201 offset:63488
    v_mfma_f32_16x16x32_bf16 v[4:7], v[52:55], v[88:91], v[4:7]
    ds_read_b64_tr_b16 v[40:41], v202 offset:61440
    ds_read_b64_tr_b16 v[42:43], v202 offset:63488
    v_mfma_f32_16x16x32_bf16 v[20:23], v[52:55], v[92:95], v[20:23]
    ds_read_b64_tr_b16 v[44:45], v203 offset:61440
    ds_read_b64_tr_b16 v[46:47], v203 offset:63488
    v_mfma_f32_16x16x32_bf16 v[8:11], v[56:59], v[88:91], v[8:11]
    v_mfma_f32_16x16x32_bf16 v[24:27], v[56:59], v[92:95], v[24:27]
    v_mfma_f32_16x16x32_bf16 v[12:15], v[60:63], v[88:91], v[12:15]
    v_mfma_f32_16x16x32_bf16 v[28:31], v[60:63], v[92:95], v[28:31]
    buffer_load_dwordx4 v[88:91], v186, s[12:15], s20 offen offset:1024 sc1
    buffer_load_dwordx4 v[92:95], v187, s[12:15], s20 offen offset:1024 sc1
    s_waitcnt vmcnt(10) lgkmcnt(8)
    v_mfma_f32_16x16x32_bf16 v[0:3], v[64:67], v[96:99], v[0:3]
    v_add_u32 v200, 65536, v200
    v_add_u32 v201, 65536, v201
    v_mfma_f32_16x16x32_bf16 v[16:19], v[64:67], v[100:103], v[16:19]
    v_add_u32 v202, 65536, v202
    v_add_u32 v203, 65536, v203
    v_mfma_f32_16x16x32_bf16 v[4:7], v[68:71], v[96:99], v[4:7]
    ds_read_b64_tr_b16 v[48:49], v200 offset:0
    ds_read_b64_tr_b16 v[50:51], v200 offset:2048
    v_mfma_f32_16x16x32_bf16 v[20:23], v[68:71], v[100:103], v[20:23]
    ds_read_b64_tr_b16 v[52:53], v201 offset:0
    ds_read_b64_tr_b16 v[54:55], v201 offset:2048
    v_mfma_f32_16x16x32_bf16 v[8:11], v[72:75], v[96:99], v[8:11]
    ds_read_b64_tr_b16 v[56:57], v202 offset:0
    ds_read_b64_tr_b16 v[58:59], v202 offset:2048
    v_mfma_f32_16x16x32_bf16 v[24:27], v[72:75], v[100:103], v[24:27]
    ds_read_b64_tr_b16 v[60:61], v203 offset:0
    ds_read_b64_tr_b16 v[62:63], v203 offset:2048
    v_mfma_f32_16x16x32_bf16 v[12:15], v[76:79], v[96:99], v[12:15]
    v_mfma_f32_16x16x32_bf16 v[28:31], v[76:79], v[100:103], v[28:31]
    buffer_load_dwordx4 v[96:99], v186, s[12:15], s20 offen offset:2048 sc1
    buffer_load_dwordx4 v[100:103], v187, s[12:15], s20 offen offset:2048 sc1
    s_waitcnt vmcnt(10) lgkmcnt(8)
    v_mfma_f32_16x16x32_bf16 v[0:3], v[32:35], v[104:107], v[0:3]
    ds_read_b64_tr_b16 v[64:65], v200 offset:4096
    ds_read_b64_tr_b16 v[66:67], v200 offset:6144
    v_mfma_f32_16x16x32_bf16 v[16:19], v[32:35], v[108:111], v[16:19]
    ds_read_b64_tr_b16 v[68:69], v201 offset:4096
    ds_read_b64_tr_b16 v[70:71], v201 offset:6144
    v_mfma_f32_16x16x32_bf16 v[4:7], v[36:39], v[104:107], v[4:7]
    ds_read_b64_tr_b16 v[72:73], v202 offset:4096
    ds_read_b64_tr_b16 v[74:75], v202 offset:6144
    v_mfma_f32_16x16x32_bf16 v[20:23], v[36:39], v[108:111], v[20:23]
    ds_read_b64_tr_b16 v[76:77], v203 offset:4096
    ds_read_b64_tr_b16 v[78:79], v203 offset:6144
    v_mfma_f32_16x16x32_bf16 v[8:11], v[40:43], v[104:107], v[8:11]
    v_mfma_f32_16x16x32_bf16 v[24:27], v[40:43], v[108:111], v[24:27]
    v_mfma_f32_16x16x32_bf16 v[12:15], v[44:47], v[104:107], v[12:15]
    v_mfma_f32_16x16x32_bf16 v[28:31], v[44:47], v[108:111], v[28:31]
    buffer_load_dwordx4 v[104:107], v186, s[12:15], s20 offen offset:3072 sc1
    buffer_load_dwordx4 v[108:111], v187, s[12:15], s20 offen offset:3072 sc1
    s_waitcnt vmcnt(10) lgkmcnt(8)
    v_mfma_f32_16x16x32_bf16 v[0:3], v[48:51], v[112:115], v[0:3]
    ds_read_b64_tr_b16 v[32:33], v200 offset:8192
    ds_read_b64_tr_b16 v[34:35], v200 offset:10240
    v_mfma_f32_16x16x32_bf16 v[16:19], v[48:51], v[116:119], v[16:19]
    ds_read_b64_tr_b16 v[36:37], v201 offset:8192
    ds_read_b64_tr_b16 v[38:39], v201 offset:10240
    v_mfma_f32_16x16x32_bf16 v[4:7], v[52:55], v[112:115], v[4:7]
    ds_read_b64_tr_b16 v[40:41], v202 offset:8192
    ds_read_b64_tr_b16 v[42:43], v202 offset:10240
    v_mfma_f32_16x16x32_bf16 v[20:23], v[52:55], v[116:119], v[20:23]
    ds_read_b64_tr_b16 v[44:45], v203 offset:8192
    ds_read_b64_tr_b16 v[46:47], v203 offset:10240
    v_mfma_f32_16x16x32_bf16 v[8:11], v[56:59], v[112:115], v[8:11]
    v_mfma_f32_16x16x32_bf16 v[24:27], v[56:59], v[116:119], v[24:27]
    v_mfma_f32_16x16x32_bf16 v[12:15], v[60:63], v[112:115], v[12:15]
    v_mfma_f32_16x16x32_bf16 v[28:31], v[60:63], v[116:119], v[28:31]
    s_add_u32 s24, s24, 4096
    s_and_b32 s24, s24, 0x3fff
    s_add_u32 s20, s21, s24
    buffer_load_dwordx4 v[112:115], v186, s[12:15], s20 offen offset:0 sc1
    buffer_load_dwordx4 v[116:119], v187, s[12:15], s20 offen offset:0 sc1
    s_waitcnt vmcnt(10) lgkmcnt(8)
    v_mfma_f32_16x16x32_bf16 v[0:3], v[64:67], v[120:123], v[0:3]
    ds_read_b64_tr_b16 v[48:49], v200 offset:12288
    ds_read_b64_tr_b16 v[50:51], v200 offset:14336
    v_mfma_f32_16x16x32_bf16 v[16:19], v[64:67], v[124:127], v[16:19]
    ds_read_b64_tr_b16 v[52:53], v201 offset:12288
    ds_read_b64_tr_b16 v[54:55], v201 offset:14336
    v_mfma_f32_16x16x32_bf16 v[4:7], v[68:71], v[120:123], v[4:7]
    ds_read_b64_tr_b16 v[56:57], v202 offset:12288
    ds_read_b64_tr_b16 v[58:59], v202 offset:14336
    v_mfma_f32_16x16x32_bf16 v[20:23], v[68:71], v[124:127], v[20:23]
    ds_read_b64_tr_b16 v[60:61], v203 offset:12288
    ds_read_b64_tr_b16 v[62:63], v203 offset:14336
    v_mfma_f32_16x16x32_bf16 v[8:11], v[72:75], v[120:123], v[8:11]
    v_mfma_f32_16x16x32_bf16 v[24:27], v[72:75], v[124:127], v[24:27]
    v_mfma_f32_16x16x32_bf16 v[12:15], v[76:79], v[120:123], v[12:15]
    v_mfma_f32_16x16x32_bf16 v[28:31], v[76:79], v[124:127], v[28:31]
    buffer_load_dwordx4 v[120:123], v186, s[12:15], s20 offen offset:1024 sc1
    buffer_load_dwordx4 v[124:127], v187, s[12:15], s20 offen offset:1024 sc1
    s_setprio 0
    s_waitcnt vmcnt(10) lgkmcnt(8)
    v_mfma_f32_16x16x32_bf16 v[0:3], v[32:35], v[80:83], v[0:3]
    ds_read_b64_tr_b16 v[64:65], v200 offset:16384
    ds_read_b64_tr_b16 v[66:67], v200 offset:18432
    v_mfma_f32_16x16x32_bf16 v[16:19], v[32:35], v[84:87], v[16:19]
    ds_read_b64_tr_b16 v[68:69], v201 offset:16384
    ds_read_b64_tr_b16 v[70:71], v201 offset:18432
    v_mfma_f32_16x16x32_bf16 v[4:7], v[36:39], v[80:83], v[4:7]
    ds_read_b64_tr_b16 v[72:73], v202 offset:16384
    ds_read_b64_tr_b16 v[74:75], v202 offset:18432
    v_mfma_f32_16x16x32_bf16 v[20:23], v[36:39], v[84:87], v[20:23]
    ds_read_b64_tr_b16 v[76:77], v203 offset:16384
    ds_read_b64_tr_b16 v[78:79], v203 offset:18432
    v_mfma_f32_16x16x32_bf16 v[8:11], v[40:43], v[80:83], v[8:11]
    v_mfma_f32_16x16x32_bf16 v[24:27], v[40:43], v[84:87], v[24:27]
    v_mfma_f32_16x16x32_bf16 v[12:15], v[44:47], v[80:83], v[12:15]
    v_mfma_f32_16x16x32_bf16 v[28:31], v[44:47], v[84:87], v[28:31]
    buffer_load_dwordx4 v[80:83], v186, s[12:15], s20 offen offset:2048 sc1
    buffer_load_dwordx4 v[84:87], v187, s[12:15], s20 offen offset:2048 sc1
    s_waitcnt vmcnt(10) lgkmcnt(8)
    v_mfma_f32_16x16x32_bf16 v[0:3], v[48:51], v[88:91], v[0:3]
    ds_read_b64_tr_b16 v[32:33], v200 offset:20480
    ds_read_b64_tr_b16 v[34:35], v200 offset:22528
    v_mfma_f32_16x16x32_bf16 v[16:19], v[48:51], v[92:95], v[16:19]
    ds_read_b64_tr_b16 v[36:37], v201 offset:20480
    ds_read_b64_tr_b16 v[38:39], v201 offset:22528
    v_mfma_f32_16x16x32_bf16 v[4:7], v[52:55], v[88:91], v[4:7]
    ds_read_b64_tr_b16 v[40:41], v202 offset:20480
    ds_read_b64_tr_b16 v[42:43], v202 offset:22528
    v_mfma_f32_16x16x32_bf16 v[20:23], v[52:55], v[92:95], v[20:23]
    ds_read_b64_tr_b16 v[44:45], v203 offset:20480
    ds_read_b64_tr_b16 v[46:47], v203 offset:22528
    v_mfma_f32_16x16x32_bf16 v[8:11], v[56:59], v[88:91], v[8:11]
    v_mfma_f32_16x16x32_bf16 v[24:27], v[56:59], v[92:95], v[24:27]
    v_mfma_f32_16x16x32_bf16 v[12:15], v[60:63], v[88:91], v[12:15]
    v_mfma_f32_16x16x32_bf16 v[28:31], v[60:63], v[92:95], v[28:31]
    buffer_load_dwordx4 v[88:91], v186, s[12:15], s20 offen offset:3072 sc1
    buffer_load_dwordx4 v[92:95], v187, s[12:15], s20 offen offset:3072 sc1
    s_waitcnt vmcnt(10) lgkmcnt(8)
    v_mfma_f32_16x16x32_bf16 v[0:3], v[64:67], v[96:99], v[0:3]
    ds_read_b64_tr_b16 v[48:49], v200 offset:24576
    ds_read_b64_tr_b16 v[50:51], v200 offset:26624
    v_mfma_f32_16x16x32_bf16 v[16:19], v[64:67], v[100:103], v[16:19]
    ds_read_b64_tr_b16 v[52:53], v201 offset:24576
    ds_read_b64_tr_b16 v[54:55], v201 offset:26624
    v_mfma_f32_16x16x32_bf16 v[4:7], v[68:71], v[96:99], v[4:7]
    ds_read_b64_tr_b16 v[56:57], v202 offset:24576
    ds_read_b64_tr_b16 v[58:59], v202 offset:26624
    v_mfma_f32_16x16x32_bf16 v[20:23], v[68:71], v[100:103], v[20:23]
    ds_read_b64_tr_b16 v[60:61], v203 offset:24576
    ds_read_b64_tr_b16 v[62:63], v203 offset:26624
    v_mfma_f32_16x16x32_bf16 v[8:11], v[72:75], v[96:99], v[8:11]
    v_mfma_f32_16x16x32_bf16 v[24:27], v[72:75], v[100:103], v[24:27]
    v_mfma_f32_16x16x32_bf16 v[12:15], v[76:79], v[96:99], v[12:15]
    v_mfma_f32_16x16x32_bf16 v[28:31], v[76:79], v[100:103], v[28:31]
    s_waitcnt vmcnt(8) lgkmcnt(8)
    v_mfma_f32_16x16x32_bf16 v[0:3], v[32:35], v[104:107], v[0:3]
    ds_read_b64_tr_b16 v[64:65], v200 offset:28672
    ds_read_b64_tr_b16 v[66:67], v200 offset:30720
    v_mfma_f32_16x16x32_bf16 v[16:19], v[32:35], v[108:111], v[16:19]
    ds_read_b64_tr_b16 v[68:69], v201 offset:28672
    ds_read_b64_tr_b16 v[70:71], v201 offset:30720
    v_mfma_f32_16x16x32_bf16 v[4:7], v[36:39], v[104:107], v[4:7]
    ds_read_b64_tr_b16 v[72:73], v202 offset:28672
    ds_read_b64_tr_b16 v[74:75], v202 offset:30720
    v_mfma_f32_16x16x32_bf16 v[20:23], v[36:39], v[108:111], v[20:23]
    ds_read_b64_tr_b16 v[76:77], v203 offset:28672
    ds_read_b64_tr_b16 v[78:79], v203 offset:30720
    v_mfma_f32_16x16x32_bf16 v[8:11], v[40:43], v[104:107], v[8:11]
    v_mfma_f32_16x16x32_bf16 v[24:27], v[40:43], v[108:111], v[24:27]
    v_mfma_f32_16x16x32_bf16 v[12:15], v[44:47], v[104:107], v[12:15]
    v_mfma_f32_16x16x32_bf16 v[28:31], v[44:47], v[108:111], v[28:31]
    s_waitcnt vmcnt(6) lgkmcnt(8)
    v_mfma_f32_16x16x32_bf16 v[0:3], v[48:51], v[112:115], v[0:3]
    ds_read_b64_tr_b16 v[32:33], v200 offset:32768
    ds_read_b64_tr_b16 v[34:35], v200 offset:34816
    v_mfma_f32_16x16x32_bf16 v[16:19], v[48:51], v[116:119], v[16:19]
    ds_read_b64_tr_b16 v[36:37], v201 offset:32768
    ds_read_b64_tr_b16 v[38:39], v201 offset:34816
    v_mfma_f32_16x16x32_bf16 v[4:7], v[52:55], v[112:115], v[4:7]
    ds_read_b64_tr_b16 v[40:41], v202 offset:32768
    ds_read_b64_tr_b16 v[42:43], v202 offset:34816
    v_mfma_f32_16x16x32_bf16 v[20:23], v[52:55], v[116:119], v[20:23]
    ds_read_b64_tr_b16 v[44:45], v203 offset:32768
    ds_read_b64_tr_b16 v[46:47], v203 offset:34816
    v_mfma_f32_16x16x32_bf16 v[8:11], v[56:59], v[112:115], v[8:11]
    v_mfma_f32_16x16x32_bf16 v[24:27], v[56:59], v[116:119], v[24:27]
    v_mfma_f32_16x16x32_bf16 v[12:15], v[60:63], v[112:115], v[12:15]
    v_mfma_f32_16x16x32_bf16 v[28:31], v[60:63], v[116:119], v[28:31]
    s_waitcnt vmcnt(4) lgkmcnt(8)
    v_mfma_f32_16x16x32_bf16 v[0:3], v[64:67], v[120:123], v[0:3]
    ds_read_b64_tr_b16 v[48:49], v200 offset:36864
    ds_read_b64_tr_b16 v[50:51], v200 offset:38912
    v_mfma_f32_16x16x32_bf16 v[16:19], v[64:67], v[124:127], v[16:19]
    ds_read_b64_tr_b16 v[52:53], v201 offset:36864
    ds_read_b64_tr_b16 v[54:55], v201 offset:38912
    v_mfma_f32_16x16x32_bf16 v[4:7], v[68:71], v[120:123], v[4:7]
    ds_read_b64_tr_b16 v[56:57], v202 offset:36864
    ds_read_b64_tr_b16 v[58:59], v202 offset:38912
    v_mfma_f32_16x16x32_bf16 v[20:23], v[68:71], v[124:127], v[20:23]
    ds_read_b64_tr_b16 v[60:61], v203 offset:36864
    ds_read_b64_tr_b16 v[62:63], v203 offset:38912
    v_mfma_f32_16x16x32_bf16 v[8:11], v[72:75], v[120:123], v[8:11]
    v_mfma_f32_16x16x32_bf16 v[24:27], v[72:75], v[124:127], v[24:27]
    v_mfma_f32_16x16x32_bf16 v[12:15], v[76:79], v[120:123], v[12:15]
    v_mfma_f32_16x16x32_bf16 v[28:31], v[76:79], v[124:127], v[28:31]
    s_waitcnt vmcnt(2) lgkmcnt(8)
    v_mfma_f32_16x16x32_bf16 v[0:3], v[32:35], v[80:83], v[0:3]
    v_mfma_f32_16x16x32_bf16 v[16:19], v[32:35], v[84:87], v[16:19]
    v_mfma_f32_16x16x32_bf16 v[4:7], v[36:39], v[80:83], v[4:7]
    v_mfma_f32_16x16x32_bf16 v[20:23], v[36:39], v[84:87], v[20:23]
    v_mfma_f32_16x16x32_bf16 v[8:11], v[40:43], v[80:83], v[8:11]
    v_mfma_f32_16x16x32_bf16 v[24:27], v[40:43], v[84:87], v[24:27]
    v_mfma_f32_16x16x32_bf16 v[12:15], v[44:47], v[80:83], v[12:15]
    v_mfma_f32_16x16x32_bf16 v[28:31], v[44:47], v[84:87], v[28:31]
    s_waitcnt vmcnt(0) lgkmcnt(0)
    v_mfma_f32_16x16x32_bf16 v[0:3], v[48:51], v[88:91], v[0:3]
    v_mfma_f32_16x16x32_bf16 v[16:19], v[48:51], v[92:95], v[16:19]
    v_mfma_f32_16x16x32_bf16 v[4:7], v[52:55], v[88:91], v[4:7]
    v_mfma_f32_16x16x32_bf16 v[20:23], v[52:55], v[92:95], v[20:23]
    v_mfma_f32_16x16x32_bf16 v[8:11], v[56:59], v[88:91], v[8:11]
    v_mfma_f32_16x16x32_bf16 v[24:27], v[56:59], v[92:95], v[24:27]
    v_mfma_f32_16x16x32_bf16 v[12:15], v[60:63], v[88:91], v[12:15]
    v_mfma_f32_16x16x32_bf16 v[28:31], v[60:63], v[92:95], v[28:31]
    s_nop 0
    v_cvt_pk_bf16_f32 v32, v0, v1
    v_cvt_pk_bf16_f32 v33, v2, v3
    v_cvt_pk_bf16_f32 v34, v4, v5
    v_cvt_pk_bf16_f32 v35, v6, v7
    v_cvt_pk_bf16_f32 v36, v8, v9
    v_cvt_pk_bf16_f32 v37, v10, v11
    v_cvt_pk_bf16_f32 v38, v12, v13
    v_cvt_pk_bf16_f32 v39, v14, v15
    v_cvt_pk_bf16_f32 v40, v16, v17
    v_cvt_pk_bf16_f32 v41, v18, v19
    v_cvt_pk_bf16_f32 v42, v20, v21
    v_cvt_pk_bf16_f32 v43, v22, v23
    v_cvt_pk_bf16_f32 v44, v24, v25
    v_cvt_pk_bf16_f32 v45, v26, v27
    v_cvt_pk_bf16_f32 v46, v28, v29
    v_cvt_pk_bf16_f32 v47, v30, v31
    v_permlane16_swap_b32 v32, v34
    v_permlane16_swap_b32 v33, v35
    v_permlane16_swap_b32 v36, v38
    v_permlane16_swap_b32 v37, v39
    v_permlane16_swap_b32 v40, v42
    v_permlane16_swap_b32 v41, v43
    v_permlane16_swap_b32 v44, v46
    v_permlane16_swap_b32 v45, v47
    s_lshl_b32 s29, s57, 8
    s_lshl_b32 s30, s16, 5
    s_add_u32 s29, s29, s30
    s_lshl_b32 s29, s29, 12
    s_lshl_b32 s30, s83, 11
    s_add_u32 s29, s29, s30
    s_lshl_b32 s30, s91, 7
    s_add_u32 s29, s29, s30
    v_and_b32 v144, 15, v255
    v_lshlrev_b32 v144, 12, v144
    v_bfe_u32 v145, v255, 4, 1
    v_lshl_add_u32 v144, v145, 5, v144
    v_lshrrev_b32 v145, 5, v255
    v_lshl_add_u32 v144, v145, 4, v144
    buffer_store_dwordx4 v[32:35], v144, s[4:7], s29 offen offset:0 sc1
    buffer_store_dwordx4 v[36:39], v144, s[4:7], s29 offen offset:64 sc1
    s_add_u32 s29, s29, 65536
    buffer_store_dwordx4 v[40:43], v144, s[4:7], s29 offen offset:0 sc1
    buffer_store_dwordx4 v[44:47], v144, s[4:7], s29 offen offset:64 sc1
L_concat_exit:
    s_endpgm
.section .rodata,"a"
.p2align 6
.amdhsa_kernel concat_heads__linear_attn_block__sliding_block__prompt_kernel
  .amdhsa_next_free_vgpr 256
  .amdhsa_next_free_sgpr 102
  .amdhsa_accum_offset 256
  .amdhsa_group_segment_fixed_size 0
  .amdhsa_kernarg_size 72
  .amdhsa_user_sgpr_count 2
  .amdhsa_user_sgpr_kernarg_segment_ptr 1
  .amdhsa_system_sgpr_workgroup_id_x 1
  .amdhsa_float_denorm_mode_32 3
  .amdhsa_float_denorm_mode_16_64 3
.end_amdhsa_kernel
```
